```python
import torch

def _softmax(x, axis=-1):
    return torch.softmax(x, dim=axis)
def _gelu(x):
    return torch.nn.functional.gelu(x, approximate="tanh")
def _silu(x):
    return torch.nn.functional.silu(x)
def _sigmoid(x):
    return torch.sigmoid(x)
def _layernorm(x, axis=-1, eps=1e-5):
    m = x.mean(dim=axis, keepdim=True)
    v = x.var(dim=axis, keepdim=True, unbiased=False)
    return (x - m) / torch.sqrt(v + eps)
def _scatter_add(tgt, idx, src, axis=0):
    return tgt.clone().index_add_(axis, idx, src)
def _segment_sum(src, seg, n):
    out = torch.zeros((n,) + src.shape[1:], dtype=src.dtype)
    return out.index_add_(0, seg, src)
def _pad(x, pw):
    flat = tuple(v for pair in reversed(pw) for v in pair)
    return torch.nn.functional.pad(x, flat)

kernel_name = 'sequential_preLN__sliding_local_dilated__glu_gated_glu__prompt'

def setup_inputs():

    _w = (lambda a: (lambda t: t.to(torch.bfloat16) if t.is_floating_point() else t)(torch.as_tensor(a)))
    def _A_setup():
        B, S, D = 1, 2048, 512
        return {
            "x": _w((lambda *s: torch.randn(*s, dtype=torch.bfloat16) * 0.05)(B, S, D)),
            "wqkv": _w((lambda *s: torch.randn(*s, dtype=torch.bfloat16) * 0.05)(D, 3 * D)),
            "wo": _w((lambda *s: torch.randn(*s, dtype=torch.bfloat16) * 0.05)(D, D)),
        }
    _A_in = _A_setup()

    def _B_setup():
        B, S, D, F = 1, 2048, 512, 1792
        return {
            "x": _w((lambda *s: torch.randn(*s, dtype=torch.bfloat16) * 0.05)(B, S, D)),
            "w_gate": _w((lambda *s: torch.randn(*s, dtype=torch.bfloat16) * 0.05)(D, F)),
            "w_up": _w((lambda *s: torch.randn(*s, dtype=torch.bfloat16) * 0.05)(D, F)),
            "w_down": _w((lambda *s: torch.randn(*s, dtype=torch.bfloat16) * 0.05)(F, D)),
        }
    _B_in = _B_setup()

    return {
        "A_x": _A_in["x"],
        "A_wqkv": _A_in["wqkv"],
        "A_wo": _A_in["wo"],
        "B_x": _B_in["x"],
        "B_w_gate": _B_in["w_gate"],
        "B_w_up": _B_in["w_up"],
        "B_w_down": _B_in["w_down"],
    }

def reference(A_x, A_wqkv, A_wo, B_x, B_w_gate, B_w_up, B_w_down):
    def _A_ref(x, wqkv, wo):
        B, S, D = x.shape
        H = 32; Dh = D // H
        W, dil = 8, 2
        qkv = (lambda x, *d: x.permute(*d))((x @ wqkv).reshape(B, S, 3, H, Dh), 2, 0, 3, 1, 4)
        q, k, v = qkv[0], qkv[1], qkv[2]
        scale = Dh ** -0.5
        pos = torch.arange(S)
        off = torch.arange(W) * dil
        idx = pos[:, None] - off[None, :]
        mask = idx >= 0
        idx_c = torch.where(mask, idx, 0).reshape(-1)
        kg = k[:, :, idx_c, :].reshape(B, H, S, W, Dh)
        vg = v[:, :, idx_c, :].reshape(B, H, S, W, Dh)
        logits = torch.einsum("bhsd,bhswd->bhsw", q, kg) * scale
        logits = torch.where(mask[None, None, :, :], logits, -1e9)
        attn = _softmax(logits, axis=-1)
        o = torch.einsum("bhsw,bhswd->bhsd", attn, vg)
        return (lambda x, *d: x.permute(*d))(o, 0, 2, 1, 3).reshape(B, S, D) @ wo

    def _B_ref(x, w_gate, w_up, w_down):
        g = torch.einsum("bsd,df->bsf", x, w_gate)
        u = torch.einsum("bsd,df->bsf", x, w_up)
        h = _sigmoid(g) * u
        return torch.einsum("bsf,fd->bsd", h, w_down)

    x = A_x
    h = x + _A_ref(_layernorm(x, axis=-1), A_wqkv, A_wo)
    h2 = h + _B_ref(_layernorm(h, axis=-1), B_w_gate, B_w_up, B_w_down)
    return h2
```

```asm
; @launch grid=(256,1,1) block=(512,1,1) lds=163840
.amdgcn_target "amdgcn-amd-amdhsa--gfx950"
.text
.globl sequential_preLN__sliding_local_dilated__glu_gated_glu__prompt_kernel
.p2align 8
.type sequential_preLN__sliding_local_dilated__glu_gated_glu__prompt_kernel,@function
sequential_preLN__sliding_local_dilated__glu_gated_glu__prompt_kernel:
  s_cmp_ge_u32 s2, 256
  s_cbranch_scc1 L_end
  s_load_dwordx4 s[96:99], s[0:1], 0
  s_load_dwordx4 s[80:83], s[0:1], 64
  s_load_dwordx2 s[94:95], s[0:1], 16
  s_load_dwordx4 s[88:91], s[0:1], 32
  s_load_dwordx4 s[84:87], s[0:1], 48
  s_and_b32 s36, s2, 7
  s_lshr_b32 s37, s2, 3
  v_lshrrev_b32 v10, 6, v0
  v_and_b32 v0, 63, v0
  v_readfirstlane_b32 s50, v10
  s_getpc_b64 s[78:79]
L_pc:
  s_sub_u32 s78, s78, L_pc - sequential_preLN__sliding_local_dilated__glu_gated_glu__prompt_kernel
  s_subb_u32 s79, s79, 0
  s_lshl_b32 s47, s37, 3
  s_add_u32 s47, s47, s50
  v_lshlrev_b32 v62, 8, v0
  v_add_u32 v62, s47, v62
  v_lshlrev_b32 v62, 7, v62
  v_min_u32 v62, CODE_BYTES - 4, v62
  s_mov_b64 exec, 3
  global_load_dword v63, v62, s[78:79]
  s_mov_b64 exec, -1
  v_and_b32 v1, 31, v0
  v_lshlrev_b32 v2, 4, v0
  v_lshrrev_b32 v3, 5, v0
  s_and_b32 s38, s50, 3
  s_and_b32 s47, s37, 1
  s_lshl_b32 s47, s47, 7
  s_lshl_b32 s51, s36, 8
  s_add_u32 s51, s51, s47
  s_lshr_b32 s64, s37, 1
  s_lshl_b32 s44, s38, 12
  s_add_u32 s44, s44, 2048
  s_and_b32 s47, s37, 3
  s_lshl_b32 s47, s47, 1
  s_lshl_b32 s62, s36, 3
  s_add_u32 s62, s62, s47
  s_lshr_b32 s63, s37, 2
  s_lshl_b32 s53, s38, 10
  s_cmp_ge_u32 s50, 4
  s_cbranch_scc1 L_helper
  s_setprio 1
  s_lshl_b32 s45, s38, 9
  s_mul_i32 s46, s38, 3072
  s_add_u32 s46, s46, 18432
  v_lshrrev_b32 v24, 3, v0
  v_lshrrev_b32 v25, 4, v0
  v_and_b32 v26, 7, v0
  s_lshl_b32 s47, s38, 5
  s_add_u32 s47, s47, s51
  v_add_u32 v27, s47, v24
  v_lshlrev_b32 v27, 10, v27
  v_xor_b32 v28, v26, v25
  v_xor_b32 v29, 4, v28
  v_lshl_add_u32 v28, v28, 4, v27
  v_lshl_add_u32 v29, v29, 4, v27
  v_add_u32 v16, 0, v28
  v_add_u32 v17, 7168, v29
  v_add_u32 v18, 14336, v28
  v_add_u32 v19, 21504, v29
  s_lshl_b32 s47, s38, 2
  v_add_u32 v27, s47, v24
  v_lshrrev_b32 v28, 1, v27
  v_and_b32 v28, 7, v28
  v_xor_b32 v28, v26, v28
  s_sub_u32 s48, s51, 16
  v_add_u32 v27, s48, v27
  v_max_i32 v27, 0, v27
  v_lshlrev_b32 v27, 10, v27
  v_lshl_add_u32 v20, v28, 4, v27
  s_mul_i32 s47, s38, 49152
  s_lshl_b32 s48, s64, 6
  s_add_u32 s47, s47, s48
  v_add_u32 v27, 0, v0
  v_mul_u32_u24 v28, 43691, v27
  v_lshrrev_b32 v28, 19, v28
  v_mul_u32_u24 v29, 12, v28
  v_sub_u32 v29, v27, v29
  v_mul_u32_u24 v28, 3072, v28
  v_lshrrev_b32 v30, 2, v29
  v_lshl_add_u32 v28, v30, 10, v28
  v_and_b32 v29, 3, v29
  v_lshl_add_u32 v28, v29, 4, v28
  v_add_u32 v28, s47, v28
  v_mov_b32 v21, v28
  v_add_u32 v27, 64, v0
  v_mul_u32_u24 v28, 43691, v27
  v_lshrrev_b32 v28, 19, v28
  v_mul_u32_u24 v29, 12, v28
  v_sub_u32 v29, v27, v29
  v_mul_u32_u24 v28, 3072, v28
  v_lshrrev_b32 v30, 2, v29
  v_lshl_add_u32 v28, v30, 10, v28
  v_and_b32 v29, 3, v29
  v_lshl_add_u32 v28, v29, 4, v28
  v_add_u32 v28, s47, v28
  v_subrev_u32 v22, 1024, v28
  v_add_u32 v27, 128, v0
  v_mul_u32_u24 v28, 43691, v27
  v_lshrrev_b32 v28, 19, v28
  v_mul_u32_u24 v29, 12, v28
  v_sub_u32 v29, v27, v29
  v_mul_u32_u24 v28, 3072, v28
  v_lshrrev_b32 v30, 2, v29
  v_lshl_add_u32 v28, v30, 10, v28
  v_and_b32 v29, 3, v29
  v_lshl_add_u32 v28, v29, 4, v28
  v_add_u32 v28, s47, v28
  v_subrev_u32 v23, 2048, v28
  s_waitcnt lgkmcnt(0)
  s_mov_b32 s4, s96
  s_and_b32 s5, s97, 0xffff
  s_mov_b32 s6, 2097152
  s_mov_b32 s7, 0x00020000
  s_mov_b32 s8, s98
  s_and_b32 s9, s99, 0xffff
  s_mov_b32 s10, 1572864
  s_mov_b32 s11, 0x00020000
  s_add_u32 m0, s44, 0
  s_mov_b32 s65, 0
  buffer_load_dwordx4 v16, s[4:7], s65 offen lds
  buffer_load_dwordx4 v17, s[4:7], s65 offen offset:1024 lds
  buffer_load_dwordx4 v18, s[4:7], s65 offen offset:2048 lds
  buffer_load_dwordx4 v19, s[4:7], s65 offen offset:3072 lds
  s_add_u32 m0, s45, 0
  s_mov_b32 s41, 0
  buffer_load_dwordx4 v20, s[4:7], s65 offen lds
  s_add_u32 m0, s46, 0
  s_nop 0
  buffer_load_dwordx4 v21, s[8:11], s41 offen lds
  buffer_load_dwordx4 v22, s[8:11], s41 offen offset:1024 lds
  buffer_load_dwordx4 v23, s[8:11], s41 offen offset:2048 lds
  s_add_u32 m0, s44, 30720
  s_mov_b32 s65, 128
  buffer_load_dwordx4 v16, s[4:7], s65 offen lds
  buffer_load_dwordx4 v17, s[4:7], s65 offen offset:1024 lds
  buffer_load_dwordx4 v18, s[4:7], s65 offen offset:2048 lds
  buffer_load_dwordx4 v19, s[4:7], s65 offen offset:3072 lds
  s_add_u32 m0, s45, 30720
  s_mov_b32 s41, 196608
  buffer_load_dwordx4 v20, s[4:7], s65 offen lds
  s_add_u32 m0, s46, 30720
  s_nop 0
  buffer_load_dwordx4 v21, s[8:11], s41 offen lds
  buffer_load_dwordx4 v22, s[8:11], s41 offen offset:1024 lds
  buffer_load_dwordx4 v23, s[8:11], s41 offen offset:2048 lds
  s_mov_b32 s28, s82
  s_and_b32 s29, s83, 0xffff
  s_mov_b32 s30, 12582912
  s_mov_b32 s31, 0x00020000
  v_lshrrev_b32 v177, 1, v1
  v_and_b32 v177, 7, v177
  v_xor_b32 v177, v177, v3
  v_lshlrev_b32 v178, 7, v1
  v_add_u32 v178, s44, v178
  v_xor_b32 v179, 0, v177
  v_lshl_add_u32 v128, v179, 4, v178
  v_add_u32 v129, 0x10000, v128
  v_xor_b32 v179, 2, v177
  v_lshl_add_u32 v130, v179, 4, v178
  v_add_u32 v131, 0x10000, v130
  v_xor_b32 v179, 4, v177
  v_lshl_add_u32 v132, v179, 4, v178
  v_add_u32 v133, 0x10000, v132
  v_xor_b32 v179, 6, v177
  v_lshl_add_u32 v134, v179, 4, v178
  v_add_u32 v135, 0x10000, v134
  v_and_b32 v180, 15, v0
  v_lshrrev_b32 v177, 1, v180
  v_lshrrev_b32 v181, 4, v0
  v_xor_b32 v177, v177, v181
  v_lshlrev_b32 v178, 7, v180
  v_xor_b32 v179, 0, v177
  v_lshl_add_u32 v136, v179, 4, v178
  v_add_u32 v137, 0x10000, v136
  v_xor_b32 v179, 4, v177
  v_lshl_add_u32 v138, v179, 4, v178
  v_add_u32 v139, 0x10000, v138
  v_lshrrev_b32 v177, 2, v180
  v_lshl_add_u32 v177, v3, 3, v177
  v_mul_u32_u24 v177, 192, v177
  v_bfe_u32 v178, v0, 4, 1
  v_lshl_add_u32 v177, v178, 5, v177
  v_and_b32 v178, 3, v0
  v_lshl_add_u32 v144, v178, 3, v177
  v_add_u32 v145, 0x10000, v144
  v_lshrrev_b32 v177, 2, v180
  v_lshl_add_u32 v177, v181, 3, v177
  v_mul_u32_u24 v177, 192, v177
  v_and_b32 v178, 3, v0
  v_lshl_add_u32 v177, v178, 3, v177
  s_min_u32 s47, s38, 2
  s_lshl_b32 s47, s47, 6
  v_add_u32 v146, s47, v177
  s_cmp_eq_u32 s38, 3
  s_cselect_b32 s48, 0, -1
  v_and_b32 v146, s48, v146
  v_add_u32 v147, 0x10000, v146
  s_cmp_eq_u32 s38, 3
  s_cselect_b32 s47, 0, 0x3f803f80
  v_mov_b32 v88, s47
  v_mov_b32 v89, s47
  v_mov_b32 v90, s47
  v_mov_b32 v91, s47
  s_sub_u32 s47, s38, 1
  s_cmp_le_u32 s47, 1
  s_cselect_b32 s42, 0xfffefffe, 0
  s_mov_b32 s43, s42
  s_lshl_b32 s47, s38, 5
  s_add_u32 s47, s47, 16
  v_add_u32 v148, s47, v1
  v_mul_u32_u24 v148, 208, v148
  v_add_u32 v148, 123136, v148
  v_mul_u32_u24 v149, 208, v180
  v_add_u32 v149, 123136, v149
  v_lshlrev_b32 v150, 6, v3
  v_add_u32 v150, 153088, v150
  s_and_b32 s48, s37, 1
  s_lshl_b32 s48, s48, 10
  s_lshl_b32 s49, s36, 12
  s_add_u32 s48, s48, s49
  s_add_u32 s48, s48, 11665408
  v_lshlrev_b32 v152, 3, v180
  v_add_u32 v152, s48, v152
  s_lshl_b32 s47, s47, 3
  s_add_u32 s48, s48, s47
  v_lshlrev_b32 v151, 3, v1
  v_add_u32 v151, s48, v151
  s_mov_b32 s24, s86
  s_and_b32 s25, s87, 0xffff
  s_mov_b32 s26, 2097152
  s_mov_b32 s27, 0x00020000
  s_mov_b32 s32, s80
  s_and_b32 s33, s81, 0xffff
  s_mov_b32 s34, 256
  s_mov_b32 s35, 0x00020000
  s_getreg_b32 s40, hwreg(HW_REG_XCC_ID, 0, 4)
  v_and_b32 v176, 15, v0
  v_lshlrev_b32 v176, 2, v176
  v_add_u32 v176, 153616, v176
  v_mov_b32 v177, 0
  ds_write_b32 v176, v177
  s_waitcnt lgkmcnt(0)
  s_waitcnt vmcnt(8)
  s_barrier
  ds_read_b128 v[80:83], v128 offset:0
  ds_read_b64_tr_b16 v[96:97], v144 offset:18432
  ds_read_b64_tr_b16 v[98:99], v144 offset:19200
  ds_read_b64_tr_b16 v[100:101], v144 offset:18496
  ds_read_b64_tr_b16 v[102:103], v144 offset:19264
  ds_read_b64_tr_b16 v[104:105], v144 offset:18560
  ds_read_b64_tr_b16 v[106:107], v144 offset:19328
  s_waitcnt lgkmcnt(4)
  v_mfma_f32_32x32x16_bf16 v[16:31], v[96:99], v[80:83], 0
  ds_read_b128 v[84:87], v130 offset:0
  ds_read_b64_tr_b16 v[112:113], v144 offset:21504
  ds_read_b64_tr_b16 v[114:115], v144 offset:22272
  s_mov_b64 exec, s[42:43]
  ds_read_b128 v[88:91], v136 offset:0
  s_mov_b64 exec, -1
  ds_read_b64_tr_b16 v[108:109], v146 offset:18432
  s_waitcnt lgkmcnt(7)
  v_mfma_f32_32x32x16_bf16 v[32:47], v[100:103], v[80:83], 0
  ds_read_b64_tr_b16 v[116:117], v144 offset:21568
  ds_read_b64_tr_b16 v[118:119], v144 offset:22336
  ds_read_b64_tr_b16 v[110:111], v146 offset:19200
  ds_read_b64_tr_b16 v[124:125], v146 offset:18464
  s_waitcnt lgkmcnt(9)
  v_mfma_f32_32x32x16_bf16 v[48:63], v[104:107], v[80:83], 0
  ds_read_b64_tr_b16 v[120:121], v144 offset:21632
  ds_read_b64_tr_b16 v[122:123], v144 offset:22400
  ds_read_b64_tr_b16 v[126:127], v146 offset:19232
  s_waitcnt lgkmcnt(9)
  v_mfma_f32_32x32x16_bf16 v[16:31], v[112:115], v[84:87], v[16:31]
  ds_read_b128 v[80:83], v132 offset:0
  ds_read_b64_tr_b16 v[96:97], v144 offset:24576
  ds_read_b64_tr_b16 v[98:99], v144 offset:25344
  s_waitcnt lgkmcnt(8)
  v_mfma_f32_32x32x16_bf16 v[32:47], v[116:119], v[84:87], v[32:47]
  ds_read_b64_tr_b16 v[100:101], v144 offset:24640
  ds_read_b64_tr_b16 v[102:103], v144 offset:25408
  s_waitcnt lgkmcnt(6)
  v_mfma_f32_32x32x16_bf16 v[48:63], v[120:123], v[84:87], v[48:63]
  ds_read_b64_tr_b16 v[104:105], v144 offset:24704
  ds_read_b64_tr_b16 v[106:107], v144 offset:25472
  s_waitcnt lgkmcnt(7)
  v_mfma_f32_16x16x32_bf16 v[64:67], v[108:111], v[88:91], 0
  v_mfma_f32_16x16x32_bf16 v[68:71], v[124:127], v[88:91], 0
  s_waitcnt lgkmcnt(4)
  v_mfma_f32_32x32x16_bf16 v[16:31], v[96:99], v[80:83], v[16:31]
  ds_read_b128 v[84:87], v134 offset:0
  ds_read_b64_tr_b16 v[112:113], v144 offset:27648
  ds_read_b64_tr_b16 v[114:115], v144 offset:28416
  s_mov_b64 exec, s[42:43]
  ds_read_b128 v[88:91], v138 offset:0
  s_mov_b64 exec, -1
  ds_read_b64_tr_b16 v[108:109], v146 offset:24576
  s_waitcnt lgkmcnt(7)
  v_mfma_f32_32x32x16_bf16 v[32:47], v[100:103], v[80:83], v[32:47]
  ds_read_b64_tr_b16 v[116:117], v144 offset:27712
  ds_read_b64_tr_b16 v[118:119], v144 offset:28480
  ds_read_b64_tr_b16 v[110:111], v146 offset:25344
  ds_read_b64_tr_b16 v[124:125], v146 offset:24608
  s_waitcnt lgkmcnt(9)
  v_mfma_f32_32x32x16_bf16 v[48:63], v[104:107], v[80:83], v[48:63]
  ds_read_b64_tr_b16 v[120:121], v144 offset:27776
  ds_read_b64_tr_b16 v[122:123], v144 offset:28544
  ds_read_b64_tr_b16 v[126:127], v146 offset:25376
  s_waitcnt lgkmcnt(0)
  s_waitcnt vmcnt(0)
  s_barrier
  v_mfma_f32_32x32x16_bf16 v[16:31], v[112:115], v[84:87], v[16:31]
  ds_read_b128 v[80:83], v128 offset:30720
  ds_read_b64_tr_b16 v[96:97], v144 offset:49152
  ds_read_b64_tr_b16 v[98:99], v144 offset:49920
  v_mfma_f32_32x32x16_bf16 v[32:47], v[116:119], v[84:87], v[32:47]
  ds_read_b64_tr_b16 v[100:101], v144 offset:49216
  ds_read_b64_tr_b16 v[102:103], v144 offset:49984
  v_mfma_f32_32x32x16_bf16 v[48:63], v[120:123], v[84:87], v[48:63]
  ds_read_b64_tr_b16 v[104:105], v144 offset:49280
  ds_read_b64_tr_b16 v[106:107], v144 offset:50048
  v_mfma_f32_16x16x32_bf16 v[64:67], v[108:111], v[88:91], v[64:67]
  v_mfma_f32_16x16x32_bf16 v[68:71], v[124:127], v[88:91], v[68:71]
  s_waitcnt lgkmcnt(4)
  v_mfma_f32_32x32x16_bf16 v[16:31], v[96:99], v[80:83], v[16:31]
  ds_read_b128 v[84:87], v130 offset:30720
  ds_read_b64_tr_b16 v[112:113], v144 offset:52224
  ds_read_b64_tr_b16 v[114:115], v144 offset:52992
  s_mov_b64 exec, s[42:43]
  ds_read_b128 v[88:91], v136 offset:30720
  s_mov_b64 exec, -1
  ds_read_b64_tr_b16 v[108:109], v146 offset:49152
  s_waitcnt lgkmcnt(7)
  v_mfma_f32_32x32x16_bf16 v[32:47], v[100:103], v[80:83], v[32:47]
  ds_read_b64_tr_b16 v[116:117], v144 offset:52288
  ds_read_b64_tr_b16 v[118:119], v144 offset:53056
  ds_read_b64_tr_b16 v[110:111], v146 offset:49920
  ds_read_b64_tr_b16 v[124:125], v146 offset:49184
  s_waitcnt lgkmcnt(9)
  v_mfma_f32_32x32x16_bf16 v[48:63], v[104:107], v[80:83], v[48:63]
  ds_read_b64_tr_b16 v[120:121], v144 offset:52352
  ds_read_b64_tr_b16 v[122:123], v144 offset:53120
  ds_read_b64_tr_b16 v[126:127], v146 offset:49952
  s_waitcnt lgkmcnt(9)
  v_mfma_f32_32x32x16_bf16 v[16:31], v[112:115], v[84:87], v[16:31]
  ds_read_b128 v[80:83], v132 offset:30720
  ds_read_b64_tr_b16 v[96:97], v144 offset:55296
  ds_read_b64_tr_b16 v[98:99], v144 offset:56064
  s_waitcnt lgkmcnt(8)
  v_mfma_f32_32x32x16_bf16 v[32:47], v[116:119], v[84:87], v[32:47]
  ds_read_b64_tr_b16 v[100:101], v144 offset:55360
  ds_read_b64_tr_b16 v[102:103], v144 offset:56128
  s_waitcnt lgkmcnt(6)
  v_mfma_f32_32x32x16_bf16 v[48:63], v[120:123], v[84:87], v[48:63]
  ds_read_b64_tr_b16 v[104:105], v144 offset:55424
  ds_read_b64_tr_b16 v[106:107], v144 offset:56192
  s_waitcnt lgkmcnt(7)
  v_mfma_f32_16x16x32_bf16 v[64:67], v[108:111], v[88:91], v[64:67]
  v_mfma_f32_16x16x32_bf16 v[68:71], v[124:127], v[88:91], v[68:71]
  s_waitcnt lgkmcnt(4)
  v_mfma_f32_32x32x16_bf16 v[16:31], v[96:99], v[80:83], v[16:31]
  ds_read_b128 v[84:87], v134 offset:30720
  ds_read_b64_tr_b16 v[112:113], v144 offset:58368
  ds_read_b64_tr_b16 v[114:115], v144 offset:59136
  s_mov_b64 exec, s[42:43]
  ds_read_b128 v[88:91], v138 offset:30720
  s_mov_b64 exec, -1
  ds_read_b64_tr_b16 v[108:109], v146 offset:55296
  s_waitcnt lgkmcnt(7)
  v_mfma_f32_32x32x16_bf16 v[32:47], v[100:103], v[80:83], v[32:47]
  ds_read_b64_tr_b16 v[116:117], v144 offset:58432
  ds_read_b64_tr_b16 v[118:119], v144 offset:59200
  ds_read_b64_tr_b16 v[110:111], v146 offset:56064
  ds_read_b64_tr_b16 v[124:125], v146 offset:55328
  s_waitcnt lgkmcnt(9)
  v_mfma_f32_32x32x16_bf16 v[48:63], v[104:107], v[80:83], v[48:63]
  ds_read_b64_tr_b16 v[120:121], v144 offset:58496
  ds_read_b64_tr_b16 v[122:123], v144 offset:59264
  ds_read_b64_tr_b16 v[126:127], v146 offset:56096
  s_waitcnt lgkmcnt(0)
  s_barrier
  v_mfma_f32_32x32x16_bf16 v[16:31], v[112:115], v[84:87], v[16:31]
  ds_read_b128 v[80:83], v128 offset:61440
  ds_read_b64_tr_b16 v[96:97], v145 offset:14336
  ds_read_b64_tr_b16 v[98:99], v145 offset:15104
  v_mfma_f32_32x32x16_bf16 v[32:47], v[116:119], v[84:87], v[32:47]
  ds_read_b64_tr_b16 v[100:101], v145 offset:14400
  ds_read_b64_tr_b16 v[102:103], v145 offset:15168
  v_mfma_f32_32x32x16_bf16 v[48:63], v[120:123], v[84:87], v[48:63]
  ds_read_b64_tr_b16 v[104:105], v145 offset:14464
  ds_read_b64_tr_b16 v[106:107], v145 offset:15232
  v_mfma_f32_16x16x32_bf16 v[64:67], v[108:111], v[88:91], v[64:67]
  v_mfma_f32_16x16x32_bf16 v[68:71], v[124:127], v[88:91], v[68:71]
  s_waitcnt lgkmcnt(4)
  v_mfma_f32_32x32x16_bf16 v[16:31], v[96:99], v[80:83], v[16:31]
  ds_read_b128 v[84:87], v130 offset:61440
  ds_read_b64_tr_b16 v[112:113], v145 offset:17408
  ds_read_b64_tr_b16 v[114:115], v145 offset:18176
  s_mov_b64 exec, s[42:43]
  ds_read_b128 v[88:91], v136 offset:61440
  s_mov_b64 exec, -1
  ds_read_b64_tr_b16 v[108:109], v147 offset:14336
  s_waitcnt lgkmcnt(7)
  v_mfma_f32_32x32x16_bf16 v[32:47], v[100:103], v[80:83], v[32:47]
  ds_read_b64_tr_b16 v[116:117], v145 offset:17472
  ds_read_b64_tr_b16 v[118:119], v145 offset:18240
  ds_read_b64_tr_b16 v[110:111], v147 offset:15104
  ds_read_b64_tr_b16 v[124:125], v147 offset:14368
  s_waitcnt lgkmcnt(9)
  v_mfma_f32_32x32x16_bf16 v[48:63], v[104:107], v[80:83], v[48:63]
  ds_read_b64_tr_b16 v[120:121], v145 offset:17536
  ds_read_b64_tr_b16 v[122:123], v145 offset:18304
  ds_read_b64_tr_b16 v[126:127], v147 offset:15136
  s_waitcnt lgkmcnt(9)
  v_mfma_f32_32x32x16_bf16 v[16:31], v[112:115], v[84:87], v[16:31]
  ds_read_b128 v[80:83], v132 offset:61440
  ds_read_b64_tr_b16 v[96:97], v145 offset:20480
  ds_read_b64_tr_b16 v[98:99], v145 offset:21248
  s_waitcnt lgkmcnt(8)
  v_mfma_f32_32x32x16_bf16 v[32:47], v[116:119], v[84:87], v[32:47]
  ds_read_b64_tr_b16 v[100:101], v145 offset:20544
  ds_read_b64_tr_b16 v[102:103], v145 offset:21312
  s_waitcnt lgkmcnt(6)
  v_mfma_f32_32x32x16_bf16 v[48:63], v[120:123], v[84:87], v[48:63]
  ds_read_b64_tr_b16 v[104:105], v145 offset:20608
  ds_read_b64_tr_b16 v[106:107], v145 offset:21376
  s_waitcnt lgkmcnt(7)
  v_mfma_f32_16x16x32_bf16 v[64:67], v[108:111], v[88:91], v[64:67]
  v_mfma_f32_16x16x32_bf16 v[68:71], v[124:127], v[88:91], v[68:71]
  s_waitcnt lgkmcnt(4)
  v_mfma_f32_32x32x16_bf16 v[16:31], v[96:99], v[80:83], v[16:31]
  ds_read_b128 v[84:87], v134 offset:61440
  ds_read_b64_tr_b16 v[112:113], v145 offset:23552
  ds_read_b64_tr_b16 v[114:115], v145 offset:24320
  s_mov_b64 exec, s[42:43]
  ds_read_b128 v[88:91], v138 offset:61440
  s_mov_b64 exec, -1
  ds_read_b64_tr_b16 v[108:109], v147 offset:20480
  s_waitcnt lgkmcnt(7)
  v_mfma_f32_32x32x16_bf16 v[32:47], v[100:103], v[80:83], v[32:47]
  ds_read_b64_tr_b16 v[116:117], v145 offset:23616
  ds_read_b64_tr_b16 v[118:119], v145 offset:24384
  ds_read_b64_tr_b16 v[110:111], v147 offset:21248
  ds_read_b64_tr_b16 v[124:125], v147 offset:20512
  s_waitcnt lgkmcnt(9)
  v_mfma_f32_32x32x16_bf16 v[48:63], v[104:107], v[80:83], v[48:63]
  ds_read_b64_tr_b16 v[120:121], v145 offset:23680
  ds_read_b64_tr_b16 v[122:123], v145 offset:24448
  ds_read_b64_tr_b16 v[126:127], v147 offset:21280
  s_waitcnt lgkmcnt(0)
  s_barrier
  v_mfma_f32_32x32x16_bf16 v[16:31], v[112:115], v[84:87], v[16:31]
  ds_read_b128 v[80:83], v129 offset:26624
  ds_read_b64_tr_b16 v[96:97], v145 offset:45056
  ds_read_b64_tr_b16 v[98:99], v145 offset:45824
  v_mfma_f32_32x32x16_bf16 v[32:47], v[116:119], v[84:87], v[32:47]
  ds_read_b64_tr_b16 v[100:101], v145 offset:45120
  ds_read_b64_tr_b16 v[102:103], v145 offset:45888
  v_mfma_f32_32x32x16_bf16 v[48:63], v[120:123], v[84:87], v[48:63]
  ds_read_b64_tr_b16 v[104:105], v145 offset:45184
  ds_read_b64_tr_b16 v[106:107], v145 offset:45952
  v_mfma_f32_16x16x32_bf16 v[64:67], v[108:111], v[88:91], v[64:67]
  v_mfma_f32_16x16x32_bf16 v[68:71], v[124:127], v[88:91], v[68:71]
  s_waitcnt lgkmcnt(4)
  v_mfma_f32_32x32x16_bf16 v[16:31], v[96:99], v[80:83], v[16:31]
  ds_read_b128 v[84:87], v131 offset:26624
  ds_read_b64_tr_b16 v[112:113], v145 offset:48128
  ds_read_b64_tr_b16 v[114:115], v145 offset:48896
  s_mov_b64 exec, s[42:43]
  ds_read_b128 v[88:91], v137 offset:26624
  s_mov_b64 exec, -1
  ds_read_b64_tr_b16 v[108:109], v147 offset:45056
  s_waitcnt lgkmcnt(7)
  v_mfma_f32_32x32x16_bf16 v[32:47], v[100:103], v[80:83], v[32:47]
  ds_read_b64_tr_b16 v[116:117], v145 offset:48192
  ds_read_b64_tr_b16 v[118:119], v145 offset:48960
  ds_read_b64_tr_b16 v[110:111], v147 offset:45824
  ds_read_b64_tr_b16 v[124:125], v147 offset:45088
  s_waitcnt lgkmcnt(9)
  v_mfma_f32_32x32x16_bf16 v[48:63], v[104:107], v[80:83], v[48:63]
  ds_read_b64_tr_b16 v[120:121], v145 offset:48256
  ds_read_b64_tr_b16 v[122:123], v145 offset:49024
  ds_read_b64_tr_b16 v[126:127], v147 offset:45856
  s_waitcnt lgkmcnt(9)
  v_mfma_f32_32x32x16_bf16 v[16:31], v[112:115], v[84:87], v[16:31]
  ds_read_b128 v[80:83], v133 offset:26624
  ds_read_b64_tr_b16 v[96:97], v145 offset:51200
  ds_read_b64_tr_b16 v[98:99], v145 offset:51968
  s_waitcnt lgkmcnt(8)
  v_mfma_f32_32x32x16_bf16 v[32:47], v[116:119], v[84:87], v[32:47]
  ds_read_b64_tr_b16 v[100:101], v145 offset:51264
  ds_read_b64_tr_b16 v[102:103], v145 offset:52032
  s_waitcnt lgkmcnt(6)
  v_mfma_f32_32x32x16_bf16 v[48:63], v[120:123], v[84:87], v[48:63]
  ds_read_b64_tr_b16 v[104:105], v145 offset:51328
  ds_read_b64_tr_b16 v[106:107], v145 offset:52096
  s_waitcnt lgkmcnt(7)
  v_mfma_f32_16x16x32_bf16 v[64:67], v[108:111], v[88:91], v[64:67]
  v_mfma_f32_16x16x32_bf16 v[68:71], v[124:127], v[88:91], v[68:71]
  s_waitcnt lgkmcnt(4)
  v_mfma_f32_32x32x16_bf16 v[16:31], v[96:99], v[80:83], v[16:31]
  ds_read_b128 v[84:87], v135 offset:26624
  ds_read_b64_tr_b16 v[112:113], v145 offset:54272
  ds_read_b64_tr_b16 v[114:115], v145 offset:55040
  s_mov_b64 exec, s[42:43]
  ds_read_b128 v[88:91], v139 offset:26624
  s_mov_b64 exec, -1
  ds_read_b64_tr_b16 v[108:109], v147 offset:51200
  s_waitcnt lgkmcnt(7)
  v_mfma_f32_32x32x16_bf16 v[32:47], v[100:103], v[80:83], v[32:47]
  ds_read_b64_tr_b16 v[116:117], v145 offset:54336
  ds_read_b64_tr_b16 v[118:119], v145 offset:55104
  ds_read_b64_tr_b16 v[110:111], v147 offset:51968
  ds_read_b64_tr_b16 v[124:125], v147 offset:51232
  s_waitcnt lgkmcnt(9)
  v_mfma_f32_32x32x16_bf16 v[48:63], v[104:107], v[80:83], v[48:63]
  ds_read_b64_tr_b16 v[120:121], v145 offset:54400
  ds_read_b64_tr_b16 v[122:123], v145 offset:55168
  ds_read_b64_tr_b16 v[126:127], v147 offset:52000
  s_waitcnt lgkmcnt(0)
  s_barrier
  v_mfma_f32_32x32x16_bf16 v[16:31], v[112:115], v[84:87], v[16:31]
  ds_read_b128 v[80:83], v128 offset:0
  ds_read_b64_tr_b16 v[96:97], v144 offset:18432
  ds_read_b64_tr_b16 v[98:99], v144 offset:19200
  v_mfma_f32_32x32x16_bf16 v[32:47], v[116:119], v[84:87], v[32:47]
  ds_read_b64_tr_b16 v[100:101], v144 offset:18496
  ds_read_b64_tr_b16 v[102:103], v144 offset:19264
  v_mfma_f32_32x32x16_bf16 v[48:63], v[120:123], v[84:87], v[48:63]
  ds_read_b64_tr_b16 v[104:105], v144 offset:18560
  ds_read_b64_tr_b16 v[106:107], v144 offset:19328
  v_mfma_f32_16x16x32_bf16 v[64:67], v[108:111], v[88:91], v[64:67]
  v_mfma_f32_16x16x32_bf16 v[68:71], v[124:127], v[88:91], v[68:71]
  s_waitcnt lgkmcnt(4)
  v_mfma_f32_32x32x16_bf16 v[16:31], v[96:99], v[80:83], v[16:31]
  ds_read_b128 v[84:87], v130 offset:0
  ds_read_b64_tr_b16 v[112:113], v144 offset:21504
  ds_read_b64_tr_b16 v[114:115], v144 offset:22272
  s_mov_b64 exec, s[42:43]
  ds_read_b128 v[88:91], v136 offset:0
  s_mov_b64 exec, -1
  ds_read_b64_tr_b16 v[108:109], v146 offset:18432
  s_waitcnt lgkmcnt(7)
  v_mfma_f32_32x32x16_bf16 v[32:47], v[100:103], v[80:83], v[32:47]
  ds_read_b64_tr_b16 v[116:117], v144 offset:21568
  ds_read_b64_tr_b16 v[118:119], v144 offset:22336
  ds_read_b64_tr_b16 v[110:111], v146 offset:19200
  ds_read_b64_tr_b16 v[124:125], v146 offset:18464
  s_waitcnt lgkmcnt(9)
  v_mfma_f32_32x32x16_bf16 v[48:63], v[104:107], v[80:83], v[48:63]
  ds_read_b64_tr_b16 v[120:121], v144 offset:21632
  ds_read_b64_tr_b16 v[122:123], v144 offset:22400
  ds_read_b64_tr_b16 v[126:127], v146 offset:19232
  s_waitcnt lgkmcnt(9)
  v_mfma_f32_32x32x16_bf16 v[16:31], v[112:115], v[84:87], v[16:31]
  ds_read_b128 v[80:83], v132 offset:0
  ds_read_b64_tr_b16 v[96:97], v144 offset:24576
  ds_read_b64_tr_b16 v[98:99], v144 offset:25344
  s_waitcnt lgkmcnt(8)
  v_mfma_f32_32x32x16_bf16 v[32:47], v[116:119], v[84:87], v[32:47]
  ds_read_b64_tr_b16 v[100:101], v144 offset:24640
  ds_read_b64_tr_b16 v[102:103], v144 offset:25408
  s_waitcnt lgkmcnt(6)
  v_mfma_f32_32x32x16_bf16 v[48:63], v[120:123], v[84:87], v[48:63]
  ds_read_b64_tr_b16 v[104:105], v144 offset:24704
  ds_read_b64_tr_b16 v[106:107], v144 offset:25472
  s_waitcnt lgkmcnt(7)
  v_mfma_f32_16x16x32_bf16 v[64:67], v[108:111], v[88:91], v[64:67]
  v_mfma_f32_16x16x32_bf16 v[68:71], v[124:127], v[88:91], v[68:71]
  s_waitcnt lgkmcnt(4)
  v_mfma_f32_32x32x16_bf16 v[16:31], v[96:99], v[80:83], v[16:31]
  ds_read_b128 v[84:87], v134 offset:0
  ds_read_b64_tr_b16 v[112:113], v144 offset:27648
  ds_read_b64_tr_b16 v[114:115], v144 offset:28416
  s_mov_b64 exec, s[42:43]
  ds_read_b128 v[88:91], v138 offset:0
  s_mov_b64 exec, -1
  ds_read_b64_tr_b16 v[108:109], v146 offset:24576
  s_waitcnt lgkmcnt(7)
  v_mfma_f32_32x32x16_bf16 v[32:47], v[100:103], v[80:83], v[32:47]
  ds_read_b64_tr_b16 v[116:117], v144 offset:27712
  ds_read_b64_tr_b16 v[118:119], v144 offset:28480
  ds_read_b64_tr_b16 v[110:111], v146 offset:25344
  ds_read_b64_tr_b16 v[124:125], v146 offset:24608
  s_waitcnt lgkmcnt(9)
  v_mfma_f32_32x32x16_bf16 v[48:63], v[104:107], v[80:83], v[48:63]
  ds_read_b64_tr_b16 v[120:121], v144 offset:27776
  ds_read_b64_tr_b16 v[122:123], v144 offset:28544
  ds_read_b64_tr_b16 v[126:127], v146 offset:25376
  s_waitcnt lgkmcnt(0)
  s_barrier
  v_mfma_f32_32x32x16_bf16 v[16:31], v[112:115], v[84:87], v[16:31]
  ds_read_b128 v[80:83], v128 offset:30720
  ds_read_b64_tr_b16 v[96:97], v144 offset:49152
  ds_read_b64_tr_b16 v[98:99], v144 offset:49920
  v_mfma_f32_32x32x16_bf16 v[32:47], v[116:119], v[84:87], v[32:47]
  ds_read_b64_tr_b16 v[100:101], v144 offset:49216
  ds_read_b64_tr_b16 v[102:103], v144 offset:49984
  v_mfma_f32_32x32x16_bf16 v[48:63], v[120:123], v[84:87], v[48:63]
  ds_read_b64_tr_b16 v[104:105], v144 offset:49280
  ds_read_b64_tr_b16 v[106:107], v144 offset:50048
  v_mfma_f32_16x16x32_bf16 v[64:67], v[108:111], v[88:91], v[64:67]
  v_mfma_f32_16x16x32_bf16 v[68:71], v[124:127], v[88:91], v[68:71]
  s_waitcnt lgkmcnt(4)
  v_mfma_f32_32x32x16_bf16 v[16:31], v[96:99], v[80:83], v[16:31]
  ds_read_b128 v[84:87], v130 offset:30720
  ds_read_b64_tr_b16 v[112:113], v144 offset:52224
  ds_read_b64_tr_b16 v[114:115], v144 offset:52992
  s_mov_b64 exec, s[42:43]
  ds_read_b128 v[88:91], v136 offset:30720
  s_mov_b64 exec, -1
  ds_read_b64_tr_b16 v[108:109], v146 offset:49152
  s_waitcnt lgkmcnt(7)
  v_mfma_f32_32x32x16_bf16 v[32:47], v[100:103], v[80:83], v[32:47]
  ds_read_b64_tr_b16 v[116:117], v144 offset:52288
  ds_read_b64_tr_b16 v[118:119], v144 offset:53056
  ds_read_b64_tr_b16 v[110:111], v146 offset:49920
  ds_read_b64_tr_b16 v[124:125], v146 offset:49184
  s_waitcnt lgkmcnt(9)
  v_mfma_f32_32x32x16_bf16 v[48:63], v[104:107], v[80:83], v[48:63]
  ds_read_b64_tr_b16 v[120:121], v144 offset:52352
  ds_read_b64_tr_b16 v[122:123], v144 offset:53120
  ds_read_b64_tr_b16 v[126:127], v146 offset:49952
  s_waitcnt lgkmcnt(9)
  v_mfma_f32_32x32x16_bf16 v[16:31], v[112:115], v[84:87], v[16:31]
  ds_read_b128 v[80:83], v132 offset:30720
  ds_read_b64_tr_b16 v[96:97], v144 offset:55296
  ds_read_b64_tr_b16 v[98:99], v144 offset:56064
  s_waitcnt lgkmcnt(8)
  v_mfma_f32_32x32x16_bf16 v[32:47], v[116:119], v[84:87], v[32:47]
  ds_read_b64_tr_b16 v[100:101], v144 offset:55360
  ds_read_b64_tr_b16 v[102:103], v144 offset:56128
  s_waitcnt lgkmcnt(6)
  v_mfma_f32_32x32x16_bf16 v[48:63], v[120:123], v[84:87], v[48:63]
  ds_read_b64_tr_b16 v[104:105], v144 offset:55424
  ds_read_b64_tr_b16 v[106:107], v144 offset:56192
  s_waitcnt lgkmcnt(7)
  v_mfma_f32_16x16x32_bf16 v[64:67], v[108:111], v[88:91], v[64:67]
  v_mfma_f32_16x16x32_bf16 v[68:71], v[124:127], v[88:91], v[68:71]
  s_waitcnt lgkmcnt(4)
  v_mfma_f32_32x32x16_bf16 v[16:31], v[96:99], v[80:83], v[16:31]
  ds_read_b128 v[84:87], v134 offset:30720
  ds_read_b64_tr_b16 v[112:113], v144 offset:58368
  ds_read_b64_tr_b16 v[114:115], v144 offset:59136
  s_mov_b64 exec, s[42:43]
  ds_read_b128 v[88:91], v138 offset:30720
  s_mov_b64 exec, -1
  ds_read_b64_tr_b16 v[108:109], v146 offset:55296
  s_waitcnt lgkmcnt(7)
  v_mfma_f32_32x32x16_bf16 v[32:47], v[100:103], v[80:83], v[32:47]
  ds_read_b64_tr_b16 v[116:117], v144 offset:58432
  ds_read_b64_tr_b16 v[118:119], v144 offset:59200
  ds_read_b64_tr_b16 v[110:111], v146 offset:56064
  ds_read_b64_tr_b16 v[124:125], v146 offset:55328
  s_waitcnt lgkmcnt(9)
  v_mfma_f32_32x32x16_bf16 v[48:63], v[104:107], v[80:83], v[48:63]
  ds_read_b64_tr_b16 v[120:121], v144 offset:58496
  ds_read_b64_tr_b16 v[122:123], v144 offset:59264
  ds_read_b64_tr_b16 v[126:127], v146 offset:56096
  s_waitcnt lgkmcnt(0)
  s_barrier
  v_mfma_f32_32x32x16_bf16 v[16:31], v[112:115], v[84:87], v[16:31]
  ds_read_b128 v[80:83], v128 offset:61440
  ds_read_b64_tr_b16 v[96:97], v145 offset:14336
  ds_read_b64_tr_b16 v[98:99], v145 offset:15104
  v_mfma_f32_32x32x16_bf16 v[32:47], v[116:119], v[84:87], v[32:47]
  ds_read_b64_tr_b16 v[100:101], v145 offset:14400
  ds_read_b64_tr_b16 v[102:103], v145 offset:15168
  v_mfma_f32_32x32x16_bf16 v[48:63], v[120:123], v[84:87], v[48:63]
  ds_read_b64_tr_b16 v[104:105], v145 offset:14464
  ds_read_b64_tr_b16 v[106:107], v145 offset:15232
  v_mfma_f32_16x16x32_bf16 v[64:67], v[108:111], v[88:91], v[64:67]
  v_mfma_f32_16x16x32_bf16 v[68:71], v[124:127], v[88:91], v[68:71]
  s_waitcnt lgkmcnt(4)
  v_mfma_f32_32x32x16_bf16 v[16:31], v[96:99], v[80:83], v[16:31]
  ds_read_b128 v[84:87], v130 offset:61440
  ds_read_b64_tr_b16 v[112:113], v145 offset:17408
  ds_read_b64_tr_b16 v[114:115], v145 offset:18176
  s_mov_b64 exec, s[42:43]
  ds_read_b128 v[88:91], v136 offset:61440
  s_mov_b64 exec, -1
  ds_read_b64_tr_b16 v[108:109], v147 offset:14336
  s_waitcnt lgkmcnt(7)
  v_mfma_f32_32x32x16_bf16 v[32:47], v[100:103], v[80:83], v[32:47]
  ds_read_b64_tr_b16 v[116:117], v145 offset:17472
  ds_read_b64_tr_b16 v[118:119], v145 offset:18240
  ds_read_b64_tr_b16 v[110:111], v147 offset:15104
  ds_read_b64_tr_b16 v[124:125], v147 offset:14368
  s_waitcnt lgkmcnt(9)
  v_mfma_f32_32x32x16_bf16 v[48:63], v[104:107], v[80:83], v[48:63]
  ds_read_b64_tr_b16 v[120:121], v145 offset:17536
  ds_read_b64_tr_b16 v[122:123], v145 offset:18304
  ds_read_b64_tr_b16 v[126:127], v147 offset:15136
  s_waitcnt lgkmcnt(9)
  v_mfma_f32_32x32x16_bf16 v[16:31], v[112:115], v[84:87], v[16:31]
  ds_read_b128 v[80:83], v132 offset:61440
  ds_read_b64_tr_b16 v[96:97], v145 offset:20480
  ds_read_b64_tr_b16 v[98:99], v145 offset:21248
  s_waitcnt lgkmcnt(8)
  v_mfma_f32_32x32x16_bf16 v[32:47], v[116:119], v[84:87], v[32:47]
  ds_read_b64_tr_b16 v[100:101], v145 offset:20544
  ds_read_b64_tr_b16 v[102:103], v145 offset:21312
  s_waitcnt lgkmcnt(6)
  v_mfma_f32_32x32x16_bf16 v[48:63], v[120:123], v[84:87], v[48:63]
  ds_read_b64_tr_b16 v[104:105], v145 offset:20608
  ds_read_b64_tr_b16 v[106:107], v145 offset:21376
  s_waitcnt lgkmcnt(7)
  v_mfma_f32_16x16x32_bf16 v[64:67], v[108:111], v[88:91], v[64:67]
  v_mfma_f32_16x16x32_bf16 v[68:71], v[124:127], v[88:91], v[68:71]
  s_waitcnt lgkmcnt(4)
  v_mfma_f32_32x32x16_bf16 v[16:31], v[96:99], v[80:83], v[16:31]
  ds_read_b128 v[84:87], v134 offset:61440
  ds_read_b64_tr_b16 v[112:113], v145 offset:23552
  ds_read_b64_tr_b16 v[114:115], v145 offset:24320
  s_mov_b64 exec, s[42:43]
  ds_read_b128 v[88:91], v138 offset:61440
  s_mov_b64 exec, -1
  ds_read_b64_tr_b16 v[108:109], v147 offset:20480
  s_waitcnt lgkmcnt(7)
  v_mfma_f32_32x32x16_bf16 v[32:47], v[100:103], v[80:83], v[32:47]
  ds_read_b64_tr_b16 v[116:117], v145 offset:23616
  ds_read_b64_tr_b16 v[118:119], v145 offset:24384
  ds_read_b64_tr_b16 v[110:111], v147 offset:21248
  ds_read_b64_tr_b16 v[124:125], v147 offset:20512
  s_waitcnt lgkmcnt(9)
  v_mfma_f32_32x32x16_bf16 v[48:63], v[104:107], v[80:83], v[48:63]
  ds_read_b64_tr_b16 v[120:121], v145 offset:23680
  ds_read_b64_tr_b16 v[122:123], v145 offset:24448
  ds_read_b64_tr_b16 v[126:127], v147 offset:21280
  s_waitcnt lgkmcnt(0)
  s_barrier
  buffer_load_dwordx2 v[154:155], v151, s[28:31], 0 offen sc1
  buffer_load_dwordx2 v[156:157], v152, s[28:31], 0 offen sc1
  v_mov_b32 v178, 153600
  ds_read_b32 v153, v178
  v_mfma_f32_32x32x16_bf16 v[16:31], v[112:115], v[84:87], v[16:31]
  ds_read_b128 v[80:83], v129 offset:26624
  ds_read_b64_tr_b16 v[96:97], v145 offset:45056
  ds_read_b64_tr_b16 v[98:99], v145 offset:45824
  v_mfma_f32_32x32x16_bf16 v[32:47], v[116:119], v[84:87], v[32:47]
  ds_read_b64_tr_b16 v[100:101], v145 offset:45120
  ds_read_b64_tr_b16 v[102:103], v145 offset:45888
  v_mfma_f32_32x32x16_bf16 v[48:63], v[120:123], v[84:87], v[48:63]
  ds_read_b64_tr_b16 v[104:105], v145 offset:45184
  ds_read_b64_tr_b16 v[106:107], v145 offset:45952
  v_mfma_f32_16x16x32_bf16 v[64:67], v[108:111], v[88:91], v[64:67]
  v_mfma_f32_16x16x32_bf16 v[68:71], v[124:127], v[88:91], v[68:71]
  s_waitcnt lgkmcnt(4)
  v_mfma_f32_32x32x16_bf16 v[16:31], v[96:99], v[80:83], v[16:31]
  ds_read_b128 v[84:87], v131 offset:26624
  ds_read_b64_tr_b16 v[112:113], v145 offset:48128
  ds_read_b64_tr_b16 v[114:115], v145 offset:48896
  s_mov_b64 exec, s[42:43]
  ds_read_b128 v[88:91], v137 offset:26624
  s_mov_b64 exec, -1
  ds_read_b64_tr_b16 v[108:109], v147 offset:45056
  s_waitcnt lgkmcnt(7)
  v_mfma_f32_32x32x16_bf16 v[32:47], v[100:103], v[80:83], v[32:47]
  ds_read_b64_tr_b16 v[116:117], v145 offset:48192
  ds_read_b64_tr_b16 v[118:119], v145 offset:48960
  ds_read_b64_tr_b16 v[110:111], v147 offset:45824
  ds_read_b64_tr_b16 v[124:125], v147 offset:45088
  s_waitcnt lgkmcnt(9)
  v_mfma_f32_32x32x16_bf16 v[48:63], v[104:107], v[80:83], v[48:63]
  ds_read_b64_tr_b16 v[120:121], v145 offset:48256
  ds_read_b64_tr_b16 v[122:123], v145 offset:49024
  ds_read_b64_tr_b16 v[126:127], v147 offset:45856
  s_waitcnt lgkmcnt(9)
  v_mfma_f32_32x32x16_bf16 v[16:31], v[112:115], v[84:87], v[16:31]
  ds_read_b128 v[80:83], v133 offset:26624
  ds_read_b64_tr_b16 v[96:97], v145 offset:51200
  ds_read_b64_tr_b16 v[98:99], v145 offset:51968
  s_waitcnt lgkmcnt(8)
  v_mfma_f32_32x32x16_bf16 v[32:47], v[116:119], v[84:87], v[32:47]
  ds_read_b64_tr_b16 v[100:101], v145 offset:51264
  ds_read_b64_tr_b16 v[102:103], v145 offset:52032
  s_waitcnt lgkmcnt(6)
  v_mfma_f32_32x32x16_bf16 v[48:63], v[120:123], v[84:87], v[48:63]
  ds_read_b64_tr_b16 v[104:105], v145 offset:51328
  ds_read_b64_tr_b16 v[106:107], v145 offset:52096
  s_waitcnt lgkmcnt(7)
  v_mfma_f32_16x16x32_bf16 v[64:67], v[108:111], v[88:91], v[64:67]
  v_mfma_f32_16x16x32_bf16 v[68:71], v[124:127], v[88:91], v[68:71]
  s_waitcnt lgkmcnt(4)
  v_mfma_f32_32x32x16_bf16 v[16:31], v[96:99], v[80:83], v[16:31]
  ds_read_b128 v[84:87], v135 offset:26624
  ds_read_b64_tr_b16 v[112:113], v145 offset:54272
  ds_read_b64_tr_b16 v[114:115], v145 offset:55040
  s_mov_b64 exec, s[42:43]
  ds_read_b128 v[88:91], v139 offset:26624
  s_mov_b64 exec, -1
  ds_read_b64_tr_b16 v[108:109], v147 offset:51200
  s_waitcnt lgkmcnt(7)
  v_mfma_f32_32x32x16_bf16 v[32:47], v[100:103], v[80:83], v[32:47]
  ds_read_b64_tr_b16 v[116:117], v145 offset:54336
  ds_read_b64_tr_b16 v[118:119], v145 offset:55104
  ds_read_b64_tr_b16 v[110:111], v147 offset:51968
  ds_read_b64_tr_b16 v[124:125], v147 offset:51232
  s_waitcnt lgkmcnt(9)
  v_mfma_f32_32x32x16_bf16 v[48:63], v[104:107], v[80:83], v[48:63]
  ds_read_b64_tr_b16 v[120:121], v145 offset:54400
  ds_read_b64_tr_b16 v[122:123], v145 offset:55168
  ds_read_b64_tr_b16 v[126:127], v147 offset:52000
  s_waitcnt lgkmcnt(0)
  s_barrier
  v_mfma_f32_32x32x16_bf16 v[16:31], v[112:115], v[84:87], v[16:31]
  v_mfma_f32_32x32x16_bf16 v[32:47], v[116:119], v[84:87], v[32:47]
  v_mfma_f32_32x32x16_bf16 v[48:63], v[120:123], v[84:87], v[48:63]
  v_mfma_f32_16x16x32_bf16 v[64:67], v[108:111], v[88:91], v[64:67]
  v_mfma_f32_16x16x32_bf16 v[68:71], v[124:127], v[88:91], v[68:71]
  v_lshrrev_b32 v177, 4, v0
  v_and_b32 v178, 1, v177
  v_lshrrev_b32 v177, 1, v177
  v_lshlrev_b32 v177, 4, v177
  v_lshl_add_u32 v177, v178, 6, v177
  v_add_u32 v177, 153088, v177
  s_lshl_b32 s47, s38, 7
  v_add_u32 v176, s47, v177
  s_mov_b32 exec_lo, 0x00010001
  s_mov_b32 exec_hi, 0x00010001
  ds_write_b128 v176, v[64:67] offset:0
  ds_write_b128 v176, v[68:71] offset:32
  s_mov_b64 exec, -1
  v_readfirstlane_b32 s47, v153
  s_nop 0
  s_cmp_lg_u32 s47, 0
  s_cbranch_scc1 C_slow
C_ret:
  s_waitcnt lgkmcnt(0)
  s_lshl_b32 s47, s38, 2
  s_add_u32 s47, s47, 153632
  v_mov_b32 v188, s47
  v_mov_b32 v189, 1
  ds_write_b32 v188, v189
  v_mov_b32 v188, 153632
C_1:
  ds_read_b128 v[12:15], v188
  s_waitcnt lgkmcnt(0)
  v_min3_u32 v12, v12, v13, v14
  v_min_u32 v12, v12, v15
  s_nop 0
  v_readfirstlane_b32 s47, v12
  s_nop 0
  s_cmp_lt_u32 s47, 1
  s_cbranch_scc1 C_1
  ds_read_b128 v[96:99], v150 offset:128
  ds_read_b128 v[100:103], v150 offset:144
  ds_read_b128 v[104:107], v150 offset:160
  ds_read_b128 v[108:111], v150 offset:176
  ds_read_b128 v[112:115], v150 offset:256
  ds_read_b128 v[116:119], v150 offset:272
  ds_read_b128 v[120:123], v150 offset:288
  ds_read_b128 v[124:127], v150 offset:304
  ds_read_b128 v[80:83], v150 offset:0
  ds_read_b128 v[84:87], v150 offset:16
  ds_read_b128 v[88:91], v150 offset:32
  ds_read_b128 v[92:95], v150 offset:48
  s_min_u32 s47, s38, 2
  s_lshl_b32 s47, s47, 7
  v_add_u32 v176, s47, v177
  ds_read_b128 v[128:131], v176 offset:0
  ds_read_b128 v[132:135], v176 offset:32
  s_waitcnt vmcnt(0)
  v_sub_f32 v158, 0, v154
  v_mov_b32 v160, v155
  v_sub_f32 v162, 0, v156
  v_mov_b32 v164, v157
  v_lshl_add_u32 v182, v3, 4, v148
  v_lshl_add_u32 v183, v3, 5, v148
  s_waitcnt lgkmcnt(10)
  v_pk_fma_f32 v[32:33], v[96:97], v[158:159], v[32:33] op_sel_hi:[1,0,1]
  v_pk_fma_f32 v[34:35], v[98:99], v[158:159], v[34:35] op_sel_hi:[1,0,1]
  v_pk_fma_f32 v[36:37], v[100:101], v[158:159], v[36:37] op_sel_hi:[1,0,1]
  v_pk_fma_f32 v[38:39], v[102:103], v[158:159], v[38:39] op_sel_hi:[1,0,1]
  v_pk_fma_f32 v[40:41], v[104:105], v[158:159], v[40:41] op_sel_hi:[1,0,1]
  v_pk_fma_f32 v[42:43], v[106:107], v[158:159], v[42:43] op_sel_hi:[1,0,1]
  v_pk_fma_f32 v[44:45], v[108:109], v[158:159], v[44:45] op_sel_hi:[1,0,1]
  v_pk_fma_f32 v[46:47], v[110:111], v[158:159], v[46:47] op_sel_hi:[1,0,1]
  v_pk_mul_f32 v[32:33], v[32:33], v[160:161] op_sel_hi:[1,0]
  v_pk_mul_f32 v[34:35], v[34:35], v[160:161] op_sel_hi:[1,0]
  v_pk_mul_f32 v[36:37], v[36:37], v[160:161] op_sel_hi:[1,0]
  v_pk_mul_f32 v[38:39], v[38:39], v[160:161] op_sel_hi:[1,0]
  v_pk_mul_f32 v[40:41], v[40:41], v[160:161] op_sel_hi:[1,0]
  v_pk_mul_f32 v[42:43], v[42:43], v[160:161] op_sel_hi:[1,0]
  v_pk_mul_f32 v[44:45], v[44:45], v[160:161] op_sel_hi:[1,0]
  v_pk_mul_f32 v[46:47], v[46:47], v[160:161] op_sel_hi:[1,0]
  v_cvt_pk_bf16_f32 v166, v32, v33
  v_cvt_pk_bf16_f32 v167, v34, v35
  v_cvt_pk_bf16_f32 v168, v36, v37
  v_cvt_pk_bf16_f32 v169, v38, v39
  v_cvt_pk_bf16_f32 v170, v40, v41
  v_cvt_pk_bf16_f32 v171, v42, v43
  v_cvt_pk_bf16_f32 v172, v44, v45
  v_cvt_pk_bf16_f32 v173, v46, v47
  ds_write_b128 v182, v[166:169]
  ds_write_b128 v182, v[170:173] offset:32
  s_waitcnt lgkmcnt(8)
  v_pk_fma_f32 v[48:49], v[112:113], v[158:159], v[48:49] op_sel_hi:[1,0,1]
  v_pk_fma_f32 v[50:51], v[114:115], v[158:159], v[50:51] op_sel_hi:[1,0,1]
  v_pk_fma_f32 v[52:53], v[116:117], v[158:159], v[52:53] op_sel_hi:[1,0,1]
  v_pk_fma_f32 v[54:55], v[118:119], v[158:159], v[54:55] op_sel_hi:[1,0,1]
  v_pk_fma_f32 v[56:57], v[120:121], v[158:159], v[56:57] op_sel_hi:[1,0,1]
  v_pk_fma_f32 v[58:59], v[122:123], v[158:159], v[58:59] op_sel_hi:[1,0,1]
  v_pk_fma_f32 v[60:61], v[124:125], v[158:159], v[60:61] op_sel_hi:[1,0,1]
  v_pk_fma_f32 v[62:63], v[126:127], v[158:159], v[62:63] op_sel_hi:[1,0,1]
  v_pk_mul_f32 v[48:49], v[48:49], v[160:161] op_sel_hi:[1,0]
  v_pk_mul_f32 v[50:51], v[50:51], v[160:161] op_sel_hi:[1,0]
  v_pk_mul_f32 v[52:53], v[52:53], v[160:161] op_sel_hi:[1,0]
  v_pk_mul_f32 v[54:55], v[54:55], v[160:161] op_sel_hi:[1,0]
  v_pk_mul_f32 v[56:57], v[56:57], v[160:161] op_sel_hi:[1,0]
  v_pk_mul_f32 v[58:59], v[58:59], v[160:161] op_sel_hi:[1,0]
  v_pk_mul_f32 v[60:61], v[60:61], v[160:161] op_sel_hi:[1,0]
  v_pk_mul_f32 v[62:63], v[62:63], v[160:161] op_sel_hi:[1,0]
  ds_write_b128 v183, v[48:51] offset:64
  ds_write_b128 v183, v[52:55] offset:80
  ds_write_b128 v183, v[56:59] offset:128
  ds_write_b128 v183, v[60:63] offset:144
  s_sub_u32 s47, s38, 1
  s_cmp_gt_u32 s47, 1
  s_cbranch_scc1 C_5
  s_waitcnt lgkmcnt(0)
  v_pk_fma_f32 v[64:65], v[128:129], v[162:163], v[64:65] op_sel_hi:[1,0,1]
  v_pk_fma_f32 v[66:67], v[130:131], v[162:163], v[66:67] op_sel_hi:[1,0,1]
  v_pk_fma_f32 v[68:69], v[132:133], v[162:163], v[68:69] op_sel_hi:[1,0,1]
  v_pk_fma_f32 v[70:71], v[134:135], v[162:163], v[70:71] op_sel_hi:[1,0,1]
  v_pk_mul_f32 v[64:65], v[64:65], v[164:165] op_sel_hi:[1,0]
  v_pk_mul_f32 v[66:67], v[66:67], v[164:165] op_sel_hi:[1,0]
  v_pk_mul_f32 v[68:69], v[68:69], v[164:165] op_sel_hi:[1,0]
  v_pk_mul_f32 v[70:71], v[70:71], v[164:165] op_sel_hi:[1,0]
  v_lshrrev_b32 v178, 4, v0
  v_and_b32 v179, 1, v178
  v_lshrrev_b32 v178, 1, v178
  s_cmp_eq_u32 s38, 1
  s_cbranch_scc1 C_3
  v_lshl_add_u32 v176, v179, 5, v149
  v_lshl_add_u32 v176, v178, 4, v176
  ds_write_b128 v176, v[64:67] offset:64
  ds_write_b128 v176, v[68:71] offset:128
  s_branch C_4
C_3:
  v_cvt_pk_bf16_f32 v166, v64, v65
  v_cvt_pk_bf16_f32 v167, v66, v67
  v_cvt_pk_bf16_f32 v168, v68, v69
  v_cvt_pk_bf16_f32 v169, v70, v71
  v_lshl_add_u32 v176, v179, 4, v149
  v_lshl_add_u32 v176, v178, 3, v176
  ds_write_b64 v176, v[166:167] offset:0
  ds_write_b64 v176, v[168:169] offset:32
C_4:
C_5:
  v_pk_fma_f32 v[16:17], v[80:81], v[158:159], v[16:17] op_sel_hi:[1,0,1]
  v_pk_fma_f32 v[18:19], v[82:83], v[158:159], v[18:19] op_sel_hi:[1,0,1]
  v_pk_fma_f32 v[20:21], v[84:85], v[158:159], v[20:21] op_sel_hi:[1,0,1]
  v_pk_fma_f32 v[22:23], v[86:87], v[158:159], v[22:23] op_sel_hi:[1,0,1]
  v_pk_fma_f32 v[24:25], v[88:89], v[158:159], v[24:25] op_sel_hi:[1,0,1]
  v_pk_fma_f32 v[26:27], v[90:91], v[158:159], v[26:27] op_sel_hi:[1,0,1]
  v_pk_fma_f32 v[28:29], v[92:93], v[158:159], v[28:29] op_sel_hi:[1,0,1]
  v_pk_fma_f32 v[30:31], v[94:95], v[158:159], v[30:31] op_sel_hi:[1,0,1]
  v_pk_mul_f32 v[16:17], v[16:17], v[160:161] op_sel_hi:[1,0]
  v_pk_mul_f32 v[18:19], v[18:19], v[160:161] op_sel_hi:[1,0]
  v_pk_mul_f32 v[20:21], v[20:21], v[160:161] op_sel_hi:[1,0]
  v_pk_mul_f32 v[22:23], v[22:23], v[160:161] op_sel_hi:[1,0]
  v_pk_mul_f32 v[24:25], v[24:25], v[160:161] op_sel_hi:[1,0]
  v_pk_mul_f32 v[26:27], v[26:27], v[160:161] op_sel_hi:[1,0]
  v_pk_mul_f32 v[28:29], v[28:29], v[160:161] op_sel_hi:[1,0]
  v_pk_mul_f32 v[30:31], v[30:31], v[160:161] op_sel_hi:[1,0]
  v_cvt_pk_bf16_f32 v174, v16, v17
  v_cvt_pk_bf16_f32 v175, v18, v19
  v_cvt_pk_bf16_f32 v176, v20, v21
  v_cvt_pk_bf16_f32 v177, v22, v23
  v_cvt_pk_bf16_f32 v178, v24, v25
  v_cvt_pk_bf16_f32 v179, v26, v27
  v_cvt_pk_bf16_f32 v180, v28, v29
  v_cvt_pk_bf16_f32 v181, v30, v31
  v_subrev_u32 v182, 2912, v182
  v_lshl_add_u32 v183, v3, 6, v148
  v_subrev_u32 v183, 2848, v183
  s_waitcnt lgkmcnt(0)
  s_lshl_b32 s47, s38, 2
  s_add_u32 s47, s47, 153632
  v_mov_b32 v188, s47
  v_mov_b32 v189, 2
  ds_write_b32 v188, v189
  v_mov_b32 v188, 153632
C_6:
  ds_read_b128 v[12:15], v188
  s_waitcnt lgkmcnt(0)
  v_min3_u32 v12, v12, v13, v14
  v_min_u32 v12, v12, v15
  s_nop 0
  v_readfirstlane_b32 s47, v12
  s_nop 0
  s_cmp_lt_u32 s47, 2
  s_cbranch_scc1 C_6
  ds_read_b128 v[80:83], v182 offset:2912
  ds_read_b128 v[84:87], v182 offset:2944
  ds_read_b128 v[88:91], v182 offset:2496
  ds_read_b128 v[92:95], v182 offset:2528
  ds_read_b128 v[96:99], v182 offset:2080
  ds_read_b128 v[100:103], v182 offset:2112
  ds_read_b128 v[104:107], v182 offset:1664
  ds_read_b128 v[108:111], v182 offset:1696
  ds_read_b128 v[112:115], v182 offset:1248
  ds_read_b128 v[116:119], v182 offset:1280
  ds_read_b128 v[120:123], v182 offset:832
  ds_read_b128 v[124:127], v182 offset:864
  ds_read_b128 v[128:131], v182 offset:416
  ds_read_b128 v[132:135], v182 offset:448
  ds_read_b128 v[136:139], v182 offset:0
  ds_read_b128 v[140:143], v182 offset:32
  s_waitcnt lgkmcnt(15)
  v_dot2_f32_bf16 v16, v174, v80, 0
  s_nop 2
  v_dot2c_f32_bf16 v16, v175, v81
  v_dot2c_f32_bf16 v16, v176, v82
  v_dot2c_f32_bf16 v16, v177, v83
  s_waitcnt lgkmcnt(14)
  v_dot2_f32_bf16 v24, v178, v84, 0
  s_nop 2
  v_dot2c_f32_bf16 v24, v179, v85
  v_dot2c_f32_bf16 v24, v180, v86
  v_dot2c_f32_bf16 v24, v181, v87
  s_waitcnt lgkmcnt(13)
  v_dot2_f32_bf16 v17, v174, v88, 0
  s_nop 2
  v_dot2c_f32_bf16 v17, v175, v89
  v_dot2c_f32_bf16 v17, v176, v90
  v_dot2c_f32_bf16 v17, v177, v91
  s_waitcnt lgkmcnt(12)
  v_dot2_f32_bf16 v25, v178, v92, 0
  s_nop 2
  v_dot2c_f32_bf16 v25, v179, v93
  v_dot2c_f32_bf16 v25, v180, v94
  v_dot2c_f32_bf16 v25, v181, v95
  s_waitcnt lgkmcnt(11)
  v_dot2_f32_bf16 v18, v174, v96, 0
  s_nop 2
  v_dot2c_f32_bf16 v18, v175, v97
  v_dot2c_f32_bf16 v18, v176, v98
  v_dot2c_f32_bf16 v18, v177, v99
  s_waitcnt lgkmcnt(10)
  v_dot2_f32_bf16 v26, v178, v100, 0
  s_nop 2
  v_dot2c_f32_bf16 v26, v179, v101
  v_dot2c_f32_bf16 v26, v180, v102
  v_dot2c_f32_bf16 v26, v181, v103
  s_waitcnt lgkmcnt(9)
  v_dot2_f32_bf16 v19, v174, v104, 0
  s_nop 2
  v_dot2c_f32_bf16 v19, v175, v105
  v_dot2c_f32_bf16 v19, v176, v106
  v_dot2c_f32_bf16 v19, v177, v107
  s_waitcnt lgkmcnt(8)
  v_dot2_f32_bf16 v27, v178, v108, 0
  s_nop 2
  v_dot2c_f32_bf16 v27, v179, v109
  v_dot2c_f32_bf16 v27, v180, v110
  v_dot2c_f32_bf16 v27, v181, v111
  s_waitcnt lgkmcnt(7)
  v_dot2_f32_bf16 v20, v174, v112, 0
  s_nop 2
  v_dot2c_f32_bf16 v20, v175, v113
  v_dot2c_f32_bf16 v20, v176, v114
  v_dot2c_f32_bf16 v20, v177, v115
  s_waitcnt lgkmcnt(6)
  v_dot2_f32_bf16 v28, v178, v116, 0
  s_nop 2
  v_dot2c_f32_bf16 v28, v179, v117
  v_dot2c_f32_bf16 v28, v180, v118
  v_dot2c_f32_bf16 v28, v181, v119
  s_waitcnt lgkmcnt(5)
  v_dot2_f32_bf16 v21, v174, v120, 0
  s_nop 2
  v_dot2c_f32_bf16 v21, v175, v121
  v_dot2c_f32_bf16 v21, v176, v122
  v_dot2c_f32_bf16 v21, v177, v123
  s_waitcnt lgkmcnt(4)
  v_dot2_f32_bf16 v29, v178, v124, 0
  s_nop 2
  v_dot2c_f32_bf16 v29, v179, v125
  v_dot2c_f32_bf16 v29, v180, v126
  v_dot2c_f32_bf16 v29, v181, v127
  s_waitcnt lgkmcnt(3)
  v_dot2_f32_bf16 v22, v174, v128, 0
  s_nop 2
  v_dot2c_f32_bf16 v22, v175, v129
  v_dot2c_f32_bf16 v22, v176, v130
  v_dot2c_f32_bf16 v22, v177, v131
  s_waitcnt lgkmcnt(2)
  v_dot2_f32_bf16 v30, v178, v132, 0
  s_nop 2
  v_dot2c_f32_bf16 v30, v179, v133
  v_dot2c_f32_bf16 v30, v180, v134
  v_dot2c_f32_bf16 v30, v181, v135
  s_waitcnt lgkmcnt(1)
  v_dot2_f32_bf16 v23, v174, v136, 0
  s_nop 2
  v_dot2c_f32_bf16 v23, v175, v137
  v_dot2c_f32_bf16 v23, v176, v138
  v_dot2c_f32_bf16 v23, v177, v139
  s_waitcnt lgkmcnt(0)
  v_dot2_f32_bf16 v31, v178, v140, 0
  s_nop 2
  v_dot2c_f32_bf16 v31, v179, v141
  v_dot2c_f32_bf16 v31, v180, v142
  v_dot2c_f32_bf16 v31, v181, v143
  ds_read_b128 v[80:83], v183 offset:2912
  ds_read_b128 v[84:87], v183 offset:2928
  ds_read_b128 v[88:91], v183 offset:2944
  ds_read_b128 v[92:95], v183 offset:2960
  ds_read_b128 v[96:99], v183 offset:2496
  ds_read_b128 v[100:103], v183 offset:2512
  ds_read_b128 v[104:107], v183 offset:2528
  ds_read_b128 v[108:111], v183 offset:2544
  ds_read_b128 v[112:115], v183 offset:2080
  ds_read_b128 v[116:119], v183 offset:2096
  ds_read_b128 v[120:123], v183 offset:2112
  ds_read_b128 v[124:127], v183 offset:2128
  v_permlane32_swap_b32 v16, v24
  v_permlane32_swap_b32 v17, v25
  v_permlane32_swap_b32 v18, v26
  v_permlane32_swap_b32 v19, v27
  v_permlane32_swap_b32 v20, v28
  v_permlane32_swap_b32 v21, v29
  v_permlane32_swap_b32 v22, v30
  v_permlane32_swap_b32 v23, v31
  v_add_f32 v16, v16, v24
  v_add_f32 v17, v17, v25
  v_add_f32 v18, v18, v26
  v_add_f32 v19, v19, v27
  v_add_f32 v20, v20, v28
  v_add_f32 v21, v21, v29
  v_add_f32 v22, v22, v30
  v_add_f32 v23, v23, v31
  s_lshl_b32 s47, s38, 5
  s_add_u32 s47, s47, s51
  s_cmp_lg_u32 s47, 0
  s_cbranch_scc1 C_8
  v_mov_b32 v32, 0xf149f2ca
  v_cmp_gt_u32 vcc, 2, v1
  s_nop 1
  v_cndmask_b32 v17, v17, v32, vcc
  v_cmp_gt_u32 vcc, 4, v1
  s_nop 1
  v_cndmask_b32 v18, v18, v32, vcc
  v_cmp_gt_u32 vcc, 6, v1
  s_nop 1
  v_cndmask_b32 v19, v19, v32, vcc
  v_cmp_gt_u32 vcc, 8, v1
  s_nop 1
  v_cndmask_b32 v20, v20, v32, vcc
  v_cmp_gt_u32 vcc, 10, v1
  s_nop 1
  v_cndmask_b32 v21, v21, v32, vcc
  v_cmp_gt_u32 vcc, 12, v1
  s_nop 1
  v_cndmask_b32 v22, v22, v32, vcc
  v_cmp_gt_u32 vcc, 14, v1
  s_nop 1
  v_cndmask_b32 v23, v23, v32, vcc
C_8:
  v_max3_f32 v32, v16, v17, v18
  v_max3_f32 v32, v32, v19, v20
  v_max3_f32 v32, v32, v21, v22
  v_max_f32 v32, v32, v23
  s_mov_b32 s47, 0x3eb8aa3b
  v_mul_f32 v33, s47, v32
  v_fma_f32 v16, v16, s47, -v33
  v_fma_f32 v17, v17, s47, -v33
  v_fma_f32 v18, v18, s47, -v33
  v_fma_f32 v19, v19, s47, -v33
  v_fma_f32 v20, v20, s47, -v33
  v_fma_f32 v21, v21, s47, -v33
  v_fma_f32 v22, v22, s47, -v33
  v_fma_f32 v23, v23, s47, -v33
  v_exp_f32 v16, v16
  v_exp_f32 v17, v17
  v_exp_f32 v18, v18
  v_exp_f32 v19, v19
  v_exp_f32 v20, v20
  v_exp_f32 v21, v21
  v_exp_f32 v22, v22
  v_exp_f32 v23, v23
  v_pk_add_f32 v[24:25], v[16:17], v[18:19]
  v_pk_add_f32 v[26:27], v[20:21], v[22:23]
  v_pk_add_f32 v[24:25], v[24:25], v[26:27]
  v_add_f32 v24, v24, v25
  v_rcp_f32 v34, v24
  ds_read_b128 v[128:131], v183 offset:1664
  ds_read_b128 v[132:135], v183 offset:1680
  ds_read_b128 v[136:139], v183 offset:1696
  ds_read_b128 v[140:143], v183 offset:1712
  s_waitcnt lgkmcnt(12)
  v_pk_mul_f32 v[48:49], v[80:81], v[16:17] op_sel_hi:[1,0]
  v_pk_mul_f32 v[50:51], v[82:83], v[16:17] op_sel_hi:[1,0]
  v_pk_mul_f32 v[52:53], v[84:85], v[16:17] op_sel_hi:[1,0]
  v_pk_mul_f32 v[54:55], v[86:87], v[16:17] op_sel_hi:[1,0]
  v_pk_mul_f32 v[56:57], v[88:89], v[16:17] op_sel_hi:[1,0]
  v_pk_mul_f32 v[58:59], v[90:91], v[16:17] op_sel_hi:[1,0]
  v_pk_mul_f32 v[60:61], v[92:93], v[16:17] op_sel_hi:[1,0]
  v_pk_mul_f32 v[62:63], v[94:95], v[16:17] op_sel_hi:[1,0]
  ds_read_b128 v[80:83], v183 offset:1248
  ds_read_b128 v[84:87], v183 offset:1264
  ds_read_b128 v[88:91], v183 offset:1280
  ds_read_b128 v[92:95], v183 offset:1296
  s_waitcnt lgkmcnt(12)
  v_pk_fma_f32 v[48:49], v[96:97], v[16:17], v[48:49] op_sel:[0,1,0] op_sel_hi:[1,1,1]
  v_pk_fma_f32 v[50:51], v[98:99], v[16:17], v[50:51] op_sel:[0,1,0] op_sel_hi:[1,1,1]
  v_pk_fma_f32 v[52:53], v[100:101], v[16:17], v[52:53] op_sel:[0,1,0] op_sel_hi:[1,1,1]
  v_pk_fma_f32 v[54:55], v[102:103], v[16:17], v[54:55] op_sel:[0,1,0] op_sel_hi:[1,1,1]
  v_pk_fma_f32 v[56:57], v[104:105], v[16:17], v[56:57] op_sel:[0,1,0] op_sel_hi:[1,1,1]
  v_pk_fma_f32 v[58:59], v[106:107], v[16:17], v[58:59] op_sel:[0,1,0] op_sel_hi:[1,1,1]
  v_pk_fma_f32 v[60:61], v[108:109], v[16:17], v[60:61] op_sel:[0,1,0] op_sel_hi:[1,1,1]
  v_pk_fma_f32 v[62:63], v[110:111], v[16:17], v[62:63] op_sel:[0,1,0] op_sel_hi:[1,1,1]
  ds_read_b128 v[96:99], v183 offset:832
  ds_read_b128 v[100:103], v183 offset:848
  ds_read_b128 v[104:107], v183 offset:864
  ds_read_b128 v[108:111], v183 offset:880
  s_waitcnt lgkmcnt(12)
  v_pk_fma_f32 v[48:49], v[112:113], v[18:19], v[48:49] op_sel_hi:[1,0,1]
  v_pk_fma_f32 v[50:51], v[114:115], v[18:19], v[50:51] op_sel_hi:[1,0,1]
  v_pk_fma_f32 v[52:53], v[116:117], v[18:19], v[52:53] op_sel_hi:[1,0,1]
  v_pk_fma_f32 v[54:55], v[118:119], v[18:19], v[54:55] op_sel_hi:[1,0,1]
  v_pk_fma_f32 v[56:57], v[120:121], v[18:19], v[56:57] op_sel_hi:[1,0,1]
  v_pk_fma_f32 v[58:59], v[122:123], v[18:19], v[58:59] op_sel_hi:[1,0,1]
  v_pk_fma_f32 v[60:61], v[124:125], v[18:19], v[60:61] op_sel_hi:[1,0,1]
  v_pk_fma_f32 v[62:63], v[126:127], v[18:19], v[62:63] op_sel_hi:[1,0,1]
  ds_read_b128 v[112:115], v183 offset:416
  ds_read_b128 v[116:119], v183 offset:432
  ds_read_b128 v[120:123], v183 offset:448
  ds_read_b128 v[124:127], v183 offset:464
  s_waitcnt lgkmcnt(12)
  v_pk_fma_f32 v[48:49], v[128:129], v[18:19], v[48:49] op_sel:[0,1,0] op_sel_hi:[1,1,1]
  v_pk_fma_f32 v[50:51], v[130:131], v[18:19], v[50:51] op_sel:[0,1,0] op_sel_hi:[1,1,1]
  v_pk_fma_f32 v[52:53], v[132:133], v[18:19], v[52:53] op_sel:[0,1,0] op_sel_hi:[1,1,1]
  v_pk_fma_f32 v[54:55], v[134:135], v[18:19], v[54:55] op_sel:[0,1,0] op_sel_hi:[1,1,1]
  v_pk_fma_f32 v[56:57], v[136:137], v[18:19], v[56:57] op_sel:[0,1,0] op_sel_hi:[1,1,1]
  v_pk_fma_f32 v[58:59], v[138:139], v[18:19], v[58:59] op_sel:[0,1,0] op_sel_hi:[1,1,1]
  v_pk_fma_f32 v[60:61], v[140:141], v[18:19], v[60:61] op_sel:[0,1,0] op_sel_hi:[1,1,1]
  v_pk_fma_f32 v[62:63], v[142:143], v[18:19], v[62:63] op_sel:[0,1,0] op_sel_hi:[1,1,1]
  ds_read_b128 v[128:131], v183 offset:0
  ds_read_b128 v[132:135], v183 offset:16
  ds_read_b128 v[136:139], v183 offset:32
  ds_read_b128 v[140:143], v183 offset:48
  s_waitcnt lgkmcnt(12)
  v_pk_fma_f32 v[48:49], v[80:81], v[20:21], v[48:49] op_sel_hi:[1,0,1]
  v_pk_fma_f32 v[50:51], v[82:83], v[20:21], v[50:51] op_sel_hi:[1,0,1]
  v_pk_fma_f32 v[52:53], v[84:85], v[20:21], v[52:53] op_sel_hi:[1,0,1]
  v_pk_fma_f32 v[54:55], v[86:87], v[20:21], v[54:55] op_sel_hi:[1,0,1]
  v_pk_fma_f32 v[56:57], v[88:89], v[20:21], v[56:57] op_sel_hi:[1,0,1]
  v_pk_fma_f32 v[58:59], v[90:91], v[20:21], v[58:59] op_sel_hi:[1,0,1]
  v_pk_fma_f32 v[60:61], v[92:93], v[20:21], v[60:61] op_sel_hi:[1,0,1]
  v_pk_fma_f32 v[62:63], v[94:95], v[20:21], v[62:63] op_sel_hi:[1,0,1]
  s_waitcnt lgkmcnt(8)
  v_pk_fma_f32 v[48:49], v[96:97], v[20:21], v[48:49] op_sel:[0,1,0] op_sel_hi:[1,1,1]
  v_pk_fma_f32 v[50:51], v[98:99], v[20:21], v[50:51] op_sel:[0,1,0] op_sel_hi:[1,1,1]
  v_pk_fma_f32 v[52:53], v[100:101], v[20:21], v[52:53] op_sel:[0,1,0] op_sel_hi:[1,1,1]
  v_pk_fma_f32 v[54:55], v[102:103], v[20:21], v[54:55] op_sel:[0,1,0] op_sel_hi:[1,1,1]
  v_pk_fma_f32 v[56:57], v[104:105], v[20:21], v[56:57] op_sel:[0,1,0] op_sel_hi:[1,1,1]
  v_pk_fma_f32 v[58:59], v[106:107], v[20:21], v[58:59] op_sel:[0,1,0] op_sel_hi:[1,1,1]
  v_pk_fma_f32 v[60:61], v[108:109], v[20:21], v[60:61] op_sel:[0,1,0] op_sel_hi:[1,1,1]
  v_pk_fma_f32 v[62:63], v[110:111], v[20:21], v[62:63] op_sel:[0,1,0] op_sel_hi:[1,1,1]
  s_waitcnt lgkmcnt(4)
  v_pk_fma_f32 v[48:49], v[112:113], v[22:23], v[48:49] op_sel_hi:[1,0,1]
  v_pk_fma_f32 v[50:51], v[114:115], v[22:23], v[50:51] op_sel_hi:[1,0,1]
  v_pk_fma_f32 v[52:53], v[116:117], v[22:23], v[52:53] op_sel_hi:[1,0,1]
  v_pk_fma_f32 v[54:55], v[118:119], v[22:23], v[54:55] op_sel_hi:[1,0,1]
  v_pk_fma_f32 v[56:57], v[120:121], v[22:23], v[56:57] op_sel_hi:[1,0,1]
  v_pk_fma_f32 v[58:59], v[122:123], v[22:23], v[58:59] op_sel_hi:[1,0,1]
  v_pk_fma_f32 v[60:61], v[124:125], v[22:23], v[60:61] op_sel_hi:[1,0,1]
  v_pk_fma_f32 v[62:63], v[126:127], v[22:23], v[62:63] op_sel_hi:[1,0,1]
  s_waitcnt lgkmcnt(0)
  v_pk_fma_f32 v[48:49], v[128:129], v[22:23], v[48:49] op_sel:[0,1,0] op_sel_hi:[1,1,1]
  v_pk_fma_f32 v[50:51], v[130:131], v[22:23], v[50:51] op_sel:[0,1,0] op_sel_hi:[1,1,1]
  v_pk_fma_f32 v[52:53], v[132:133], v[22:23], v[52:53] op_sel:[0,1,0] op_sel_hi:[1,1,1]
  v_pk_fma_f32 v[54:55], v[134:135], v[22:23], v[54:55] op_sel:[0,1,0] op_sel_hi:[1,1,1]
  v_pk_fma_f32 v[56:57], v[136:137], v[22:23], v[56:57] op_sel:[0,1,0] op_sel_hi:[1,1,1]
  v_pk_fma_f32 v[58:59], v[138:139], v[22:23], v[58:59] op_sel:[0,1,0] op_sel_hi:[1,1,1]
  v_pk_fma_f32 v[60:61], v[140:141], v[22:23], v[60:61] op_sel:[0,1,0] op_sel_hi:[1,1,1]
  v_pk_fma_f32 v[62:63], v[142:143], v[22:23], v[62:63] op_sel:[0,1,0] op_sel_hi:[1,1,1]
  v_pk_mul_f32 v[48:49], v[48:49], v[34:35] op_sel_hi:[1,0]
  v_pk_mul_f32 v[50:51], v[50:51], v[34:35] op_sel_hi:[1,0]
  v_pk_mul_f32 v[52:53], v[52:53], v[34:35] op_sel_hi:[1,0]
  v_pk_mul_f32 v[54:55], v[54:55], v[34:35] op_sel_hi:[1,0]
  v_pk_mul_f32 v[56:57], v[56:57], v[34:35] op_sel_hi:[1,0]
  v_pk_mul_f32 v[58:59], v[58:59], v[34:35] op_sel_hi:[1,0]
  v_pk_mul_f32 v[60:61], v[60:61], v[34:35] op_sel_hi:[1,0]
  v_pk_mul_f32 v[62:63], v[62:63], v[34:35] op_sel_hi:[1,0]
  v_cvt_pk_bf16_f32 v64, v48, v49
  v_cvt_pk_bf16_f32 v65, v50, v51
  v_cvt_pk_bf16_f32 v66, v52, v53
  v_cvt_pk_bf16_f32 v67, v54, v55
  v_cvt_pk_bf16_f32 v68, v56, v57
  v_cvt_pk_bf16_f32 v69, v58, v59
  v_cvt_pk_bf16_f32 v70, v60, v61
  v_cvt_pk_bf16_f32 v71, v62, v63
  v_permlane32_swap_b32 v64, v68
  v_permlane32_swap_b32 v65, v69
  v_permlane32_swap_b32 v66, v70
  v_permlane32_swap_b32 v67, v71
  s_lshr_b32 s47, s51, 5
  s_add_u32 s47, s47, s38
  s_lshl_b32 s47, s47, 5
  s_lshl_b32 s48, s64, 1
  s_add_u32 s47, s47, s48
  s_lshl_b32 s49, s47, 10
  buffer_store_dwordx4 v[64:67], v2, s[28:31], s49 offen sc1
  buffer_store_dwordx4 v[68:71], v2, s[28:31], s49 offen offset:1024 sc1
  s_waitcnt vmcnt(0)
  s_barrier
  v_and_b32 v179, 15, v0
  v_lshrrev_b32 v180, 2, v179
  v_lshl_add_u32 v180, v3, 2, v180
  v_lshlrev_b32 v180, 7, v180
  v_add_u32 v180, s53, v180
  v_and_b32 v181, 1, v0
  v_lshl_add_u32 v180, v181, 3, v180
  v_bfe_u32 v181, v0, 1, 1
  v_bfe_u32 v182, v0, 4, 1
  v_lshl_add_u32 v181, v182, 1, v181
  v_bfe_u32 v182, v0, 3, 1
  v_lshlrev_b32 v182, 2, v182
  v_xor_b32 v181, v181, v182
  s_and_b32 s47, s38, 1
  s_lshl_b32 s47, s47, 2
  v_xor_b32 v182, s47, v181
  v_lshl_add_u32 v160, v182, 4, v180
  v_add_u32 v161, 0x10000, v160
  v_add_u32 v162, 0x20000, v160
  v_xor_b32 v182, s47, v181
  v_xor_b32 v182, 4, v182
  v_lshl_add_u32 v163, v182, 4, v180
  v_add_u32 v164, 0x10000, v163
  v_add_u32 v165, 0x20000, v163
  v_add_u32 v166, s53, v2
  v_add_u32 v167, 0x10000, v166
  v_add_u32 v168, 0x20000, v166
  v_xor_b32 v169, 1024, v166
  v_add_u32 v170, 0x10000, v169
  v_add_u32 v171, 0x20000, v169
  v_xor_b32 v172, 2048, v166
  v_add_u32 v173, 0x10000, v172
  v_add_u32 v174, 0x20000, v172
  v_xor_b32 v175, 3072, v166
  v_add_u32 v176, 0x10000, v175
  v_add_u32 v177, 0x20000, v175
  s_lshr_b32 s47, s38, 1
  s_add_u32 s47, s47, s62
  s_lshl_b32 s47, s47, 15
  s_and_b32 s48, s38, 1
  s_lshl_b32 s48, s48, 6
  s_add_u32 s47, s47, s48
  s_lshl_b32 s48, s63, 7
  s_add_u32 s47, s47, s48
  v_lshlrev_b32 v176, 10, v1
  v_lshl_add_u32 v176, v3, 3, v176
  buffer_load_dwordx2 v[4:5], v176, s[4:7], s47 offen
  buffer_load_dwordx2 v[6:7], v176, s[4:7], s47 offen offset:16
  buffer_load_dwordx2 v[8:9], v176, s[4:7], s47 offen offset:32
  buffer_load_dwordx2 v[10:11], v176, s[4:7], s47 offen offset:48
  s_and_b32 s47, s37, 3
  s_lshl_b32 s47, s47, 1
  s_lshr_b32 s48, s38, 1
  s_add_u32 s47, s47, s48
  s_lshl_b32 s47, s47, 8
  s_lshl_b32 s48, s36, 12
  s_add_u32 s47, s47, s48
  s_add_u32 s47, s47, 11665536
  v_lshlrev_b32 v177, 3, v1
  buffer_load_dword v15, v177, s[28:31], s47 offen sc1
  s_lshr_b32 s47, s38, 1
  s_xor_b32 s47, s47, 0
  s_add_u32 s47, s47, s62
  s_lshl_b32 s47, s47, 5
  s_lshl_b32 s48, s38, 3
  s_add_u32 s47, s47, s48
  s_lshl_b32 s66, s47, 10
  s_add_u32 s67, s66, 4096
  s_lshr_b32 s47, s38, 1
  s_xor_b32 s47, s47, 1
  s_add_u32 s47, s47, s62
  s_lshl_b32 s47, s47, 5
  s_lshl_b32 s48, s38, 3
  s_add_u32 s47, s47, s48
  s_lshl_b32 s68, s47, 10
  s_add_u32 s69, s68, 4096
  v_mov_b32 v128, 0
  v_mov_b32 v129, 0
  v_mov_b32 v130, 0
  v_mov_b32 v131, 0
  v_mov_b32 v132, 0
  v_mov_b32 v133, 0
  v_mov_b32 v134, 0
  v_mov_b32 v135, 0
  v_mov_b32 v136, 0
  v_mov_b32 v137, 0
  v_mov_b32 v138, 0
  v_mov_b32 v139, 0
  v_mov_b32 v140, 0
  v_mov_b32 v141, 0
  v_mov_b32 v142, 0
  v_mov_b32 v143, 0
  v_mov_b32 v144, 0
  v_mov_b32 v145, 0
  v_mov_b32 v146, 0
  v_mov_b32 v147, 0
  v_mov_b32 v148, 0
  v_mov_b32 v149, 0
  v_mov_b32 v150, 0
  v_mov_b32 v151, 0
  v_mov_b32 v152, 0
  v_mov_b32 v153, 0
  v_mov_b32 v154, 0
  v_mov_b32 v155, 0
  v_mov_b32 v156, 0
  v_mov_b32 v157, 0
  v_mov_b32 v158, 0
  v_mov_b32 v159, 0
  v_and_b32 v14, 1, v0
  v_lshlrev_b32 v14, 8, v14
  v_lshl_add_u32 v14, v3, 4, v14
  s_lshl_b32 s48, s38, 9
  s_add_u32 s48, s48, 153856
  v_add_u32 v14, s48, v14
  s_waitcnt vmcnt(0)
  s_barrier
  buffer_load_dwordx4 a[0:3], v2, s[28:31], s66 offen offset:0 sc1
  buffer_load_dwordx4 a[4:7], v2, s[28:31], s68 offen offset:0 sc1
  buffer_load_dwordx4 a[8:11], v2, s[28:31], s66 offen offset:1024 sc1
  buffer_load_dwordx4 a[12:15], v2, s[28:31], s68 offen offset:1024 sc1
  buffer_load_dwordx4 a[16:19], v2, s[28:31], s66 offen offset:2048 sc1
  buffer_load_dwordx4 a[20:23], v2, s[28:31], s68 offen offset:2048 sc1
  ds_read_b64_tr_b16 v[112:113], v160 offset:0
  ds_read_b64_tr_b16 v[114:115], v160 offset:4096
  ds_read_b64_tr_b16 v[116:117], v163 offset:0
  ds_read_b64_tr_b16 v[118:119], v163 offset:4096
  s_waitcnt vmcnt(4)
  s_waitcnt lgkmcnt(2)
  v_mfma_f32_32x32x16_bf16 v[16:31], v[112:115], a[0:3], 0
  ds_read_b64_tr_b16 v[120:121], v160 offset:8192
  buffer_load_dwordx4 a[24:27], v2, s[28:31], s66 offen offset:3072 sc1
  v_mfma_f32_32x32x16_bf16 v[48:63], v[112:115], a[4:7], 0
  ds_read_b64_tr_b16 v[122:123], v160 offset:12288
  buffer_load_dwordx4 a[28:31], v2, s[28:31], s68 offen offset:3072 sc1
  s_waitcnt lgkmcnt(2)
  v_mfma_f32_32x32x16_bf16 v[32:47], v[116:119], a[0:3], 0
  ds_read_b64_tr_b16 v[124:125], v163 offset:8192
  v_mfma_f32_32x32x16_bf16 v[64:79], v[116:119], a[4:7], 0
  ds_read_b64_tr_b16 v[126:127], v163 offset:12288
  s_waitcnt vmcnt(4)
  s_waitcnt lgkmcnt(2)
  v_mfma_f32_32x32x16_bf16 v[16:31], v[120:123], a[8:11], v[16:31]
  ds_read_b64_tr_b16 v[112:113], v160 offset:16384
  buffer_load_dwordx4 a[32:35], v2, s[28:31], s67 offen offset:0 sc1
  v_mfma_f32_32x32x16_bf16 v[48:63], v[120:123], a[12:15], v[48:63]
  ds_read_b64_tr_b16 v[114:115], v160 offset:20480
  buffer_load_dwordx4 a[36:39], v2, s[28:31], s69 offen offset:0 sc1
  s_waitcnt lgkmcnt(2)
  v_mfma_f32_32x32x16_bf16 v[32:47], v[124:127], a[8:11], v[32:47]
  ds_read_b64_tr_b16 v[116:117], v163 offset:16384
  v_mfma_f32_32x32x16_bf16 v[64:79], v[124:127], a[12:15], v[64:79]
  ds_read_b64_tr_b16 v[118:119], v163 offset:20480
  s_waitcnt vmcnt(4)
  s_waitcnt lgkmcnt(2)
  v_mfma_f32_32x32x16_bf16 v[16:31], v[112:115], a[16:19], v[16:31]
  ds_read_b64_tr_b16 v[120:121], v160 offset:24576
  buffer_load_dwordx4 a[40:43], v2, s[28:31], s67 offen offset:1024 sc1
  v_mfma_f32_32x32x16_bf16 v[48:63], v[112:115], a[20:23], v[48:63]
  ds_read_b64_tr_b16 v[122:123], v160 offset:28672
  buffer_load_dwordx4 a[44:47], v2, s[28:31], s69 offen offset:1024 sc1
  s_waitcnt lgkmcnt(2)
  v_mfma_f32_32x32x16_bf16 v[32:47], v[116:119], a[16:19], v[32:47]
  ds_read_b64_tr_b16 v[124:125], v163 offset:24576
  v_mfma_f32_32x32x16_bf16 v[64:79], v[116:119], a[20:23], v[64:79]
  ds_read_b64_tr_b16 v[126:127], v163 offset:28672
  s_waitcnt vmcnt(4)
  s_waitcnt lgkmcnt(2)
  v_mfma_f32_32x32x16_bf16 v[16:31], v[120:123], a[24:27], v[16:31]
  ds_read_b64_tr_b16 v[112:113], v160 offset:32768
  buffer_load_dwordx4 a[48:51], v2, s[28:31], s67 offen offset:2048 sc1
  v_mfma_f32_32x32x16_bf16 v[48:63], v[120:123], a[28:31], v[48:63]
  ds_read_b64_tr_b16 v[114:115], v160 offset:36864
  buffer_load_dwordx4 a[52:55], v2, s[28:31], s69 offen offset:2048 sc1
  s_waitcnt lgkmcnt(2)
  v_mfma_f32_32x32x16_bf16 v[32:47], v[124:127], a[24:27], v[32:47]
  ds_read_b64_tr_b16 v[116:117], v163 offset:32768
  v_mfma_f32_32x32x16_bf16 v[64:79], v[124:127], a[28:31], v[64:79]
  ds_read_b64_tr_b16 v[118:119], v163 offset:36864
  s_waitcnt vmcnt(4)
  s_waitcnt lgkmcnt(2)
  v_mfma_f32_32x32x16_bf16 v[16:31], v[112:115], a[32:35], v[16:31]
  ds_read_b64_tr_b16 v[120:121], v160 offset:40960
  buffer_load_dwordx4 a[56:59], v2, s[28:31], s67 offen offset:3072 sc1
  v_mfma_f32_32x32x16_bf16 v[48:63], v[112:115], a[36:39], v[48:63]
  ds_read_b64_tr_b16 v[122:123], v160 offset:45056
  buffer_load_dwordx4 a[60:63], v2, s[28:31], s69 offen offset:3072 sc1
  s_waitcnt lgkmcnt(2)
  v_mfma_f32_32x32x16_bf16 v[32:47], v[116:119], a[32:35], v[32:47]
  ds_read_b64_tr_b16 v[124:125], v163 offset:40960
  v_mfma_f32_32x32x16_bf16 v[64:79], v[116:119], a[36:39], v[64:79]
  ds_read_b64_tr_b16 v[126:127], v163 offset:45056
  s_waitcnt vmcnt(4)
  s_waitcnt lgkmcnt(2)
  v_mfma_f32_32x32x16_bf16 v[16:31], v[120:123], a[40:43], v[16:31]
  ds_read_b64_tr_b16 v[112:113], v160 offset:49152
  v_mfma_f32_32x32x16_bf16 v[48:63], v[120:123], a[44:47], v[48:63]
  ds_read_b64_tr_b16 v[114:115], v160 offset:53248
  s_waitcnt lgkmcnt(2)
  v_mfma_f32_32x32x16_bf16 v[32:47], v[124:127], a[40:43], v[32:47]
  ds_read_b64_tr_b16 v[116:117], v163 offset:49152
  v_mfma_f32_32x32x16_bf16 v[64:79], v[124:127], a[44:47], v[64:79]
  ds_read_b64_tr_b16 v[118:119], v163 offset:53248
  s_barrier
  s_mov_b32 exec_lo, 0x000c0003
  s_mov_b32 exec_hi, 0x000c0003
  ds_read_b128 v[128:131], v14 offset:0
  ds_read_b128 v[132:135], v14 offset:32
  ds_read_b128 v[136:139], v14 offset:64
  ds_read_b128 v[140:143], v14 offset:96
  ds_read_b128 v[144:147], v14 offset:128
  ds_read_b128 v[148:151], v14 offset:160
  ds_read_b128 v[152:155], v14 offset:192
  ds_read_b128 v[156:159], v14 offset:224
  s_mov_b64 exec, -1
  s_waitcnt vmcnt(2)
  s_waitcnt lgkmcnt(10)
  v_mfma_f32_32x32x16_bf16 v[16:31], v[112:115], a[48:51], v[16:31]
  ds_read_b64_tr_b16 v[120:121], v160 offset:57344
  v_mfma_f32_32x32x16_bf16 v[48:63], v[112:115], a[52:55], v[48:63]
  ds_read_b64_tr_b16 v[122:123], v160 offset:61440
  s_waitcnt lgkmcnt(10)
  v_mfma_f32_32x32x16_bf16 v[32:47], v[116:119], a[48:51], v[32:47]
  ds_read_b64_tr_b16 v[124:125], v163 offset:57344
  v_mfma_f32_32x32x16_bf16 v[64:79], v[116:119], a[52:55], v[64:79]
  ds_read_b64_tr_b16 v[126:127], v163 offset:61440
  s_waitcnt vmcnt(0)
  s_waitcnt lgkmcnt(2)
  v_mfma_f32_32x32x16_bf16 v[16:31], v[120:123], a[56:59], v[16:31]
  v_mfma_f32_32x32x16_bf16 v[48:63], v[120:123], a[60:63], v[48:63]
  s_waitcnt lgkmcnt(0)
  v_mfma_f32_32x32x16_bf16 v[32:47], v[124:127], a[56:59], v[32:47]
  v_mfma_f32_32x32x16_bf16 v[64:79], v[124:127], a[60:63], v[64:79]
  v_mfma_f32_16x16x32_bf16 v[80:83], v[128:131], a[0:3], 0
  v_mfma_f32_16x16x32_bf16 v[84:87], v[128:131], a[4:7], 0
  v_mfma_f32_16x16x32_bf16 v[80:83], v[132:135], a[8:11], v[80:83]
  v_mfma_f32_16x16x32_bf16 v[84:87], v[132:135], a[12:15], v[84:87]
  s_nop 6
  ds_write_b128 v166, v[32:35] offset:0
  ds_write_b128 v166, v[36:39] offset:4096
  ds_write_b128 v166, v[40:43] offset:8192
  ds_write_b128 v166, v[44:47] offset:12288
  v_mfma_f32_16x16x32_bf16 v[80:83], v[136:139], a[16:19], v[80:83]
  v_mfma_f32_16x16x32_bf16 v[84:87], v[136:139], a[20:23], v[84:87]
  v_mfma_f32_16x16x32_bf16 v[80:83], v[140:143], a[24:27], v[80:83]
  v_mfma_f32_16x16x32_bf16 v[84:87], v[140:143], a[28:31], v[84:87]
  ds_write_b128 v166, v[48:51] offset:16384
  ds_write_b128 v166, v[52:55] offset:20480
  ds_write_b128 v166, v[56:59] offset:24576
  ds_write_b128 v166, v[60:63] offset:28672
  v_mfma_f32_16x16x32_bf16 v[80:83], v[144:147], a[32:35], v[80:83]
  v_mfma_f32_16x16x32_bf16 v[84:87], v[144:147], a[36:39], v[84:87]
  v_mfma_f32_16x16x32_bf16 v[80:83], v[148:151], a[40:43], v[80:83]
  v_mfma_f32_16x16x32_bf16 v[84:87], v[148:151], a[44:47], v[84:87]
  ds_write_b128 v166, v[64:67] offset:32768
  ds_write_b128 v166, v[68:71] offset:36864
  ds_write_b128 v166, v[72:75] offset:40960
  ds_write_b128 v166, v[76:79] offset:45056
  v_mfma_f32_16x16x32_bf16 v[80:83], v[152:155], a[48:51], v[80:83]
  v_mfma_f32_16x16x32_bf16 v[84:87], v[152:155], a[52:55], v[84:87]
  v_mfma_f32_16x16x32_bf16 v[80:83], v[156:159], a[56:59], v[80:83]
  v_mfma_f32_16x16x32_bf16 v[84:87], v[156:159], a[60:63], v[84:87]
  v_and_b32 v186, 15, v0
  v_lshlrev_b32 v186, 2, v186
  s_lshr_b32 s47, s38, 1
  s_lshl_b32 s47, s47, 7
  s_add_u32 s48, s47, s53
  s_add_u32 s48, s48, 49152
  v_add_u32 v187, s48, v186
  v_xor_b32 v188, 128, v187
  v_lshlrev_b32 v144, 16, v4
  v_and_b32 v145, 0xffff0000, v4
  v_lshlrev_b32 v146, 16, v5
  v_and_b32 v147, 0xffff0000, v5
  v_lshlrev_b32 v148, 16, v6
  v_and_b32 v149, 0xffff0000, v6
  v_lshlrev_b32 v150, 16, v7
  v_and_b32 v151, 0xffff0000, v7
  v_lshlrev_b32 v152, 16, v8
  v_and_b32 v153, 0xffff0000, v8
  v_lshlrev_b32 v154, 16, v9
  v_and_b32 v155, 0xffff0000, v9
  v_lshlrev_b32 v156, 16, v10
  v_and_b32 v157, 0xffff0000, v10
  v_lshlrev_b32 v158, 16, v11
  v_and_b32 v159, 0xffff0000, v11
  v_pk_add_f32 v[16:17], v[16:17], v[144:145]
  v_pk_add_f32 v[18:19], v[18:19], v[146:147]
  v_pk_add_f32 v[20:21], v[20:21], v[148:149]
  v_pk_add_f32 v[22:23], v[22:23], v[150:151]
  v_pk_add_f32 v[24:25], v[24:25], v[152:153]
  v_pk_add_f32 v[26:27], v[26:27], v[154:155]
  v_pk_add_f32 v[28:29], v[28:29], v[156:157]
  v_pk_add_f32 v[30:31], v[30:31], v[158:159]
  v_add_f32 v80, v80, v81
  v_add_f32 v82, v82, v83
  v_add_f32 v84, v84, v85
  v_add_f32 v86, v86, v87
  s_mov_b32 exec_lo, 0xffff
  s_mov_b32 exec_hi, 0
  ds_write_b32 v187, v80
  ds_write_b32 v187, v82 offset:64
  ds_write_b32 v188, v84
  ds_write_b32 v188, v86 offset:64
  s_mov_b64 exec, -1
  v_lshlrev_b32 v189, 2, v1
  s_add_u32 s47, s47, 49152
  v_add_u32 v189, s47, v189
  s_lshr_b32 s47, s38, 1
  s_add_u32 s47, s47, s62
  s_lshl_b32 s48, s47, 5
  s_lshl_b32 s49, s63, 1
  s_add_u32 s48, s48, s49
  s_and_b32 s49, s38, 1
  s_add_u32 s48, s48, s49
  v_and_b32 v13, 15, v1
  v_lshl_add_u32 v13, v3, 4, v13
  v_lshlrev_b32 v13, 4, v13
  v_lshrrev_b32 v12, 4, v1
  v_lshl_add_u32 v13, v12, 14, v13
  s_lshl_b32 s48, s48, 10
  s_add_u32 s66, s48, 2097152
  s_lshl_b32 s47, s47, 11
  s_lshl_b32 s50, s63, 1
  s_add_u32 s50, s50, s49
  s_lshl_b32 s50, s50, 2
  s_add_u32 s47, s47, s50
  s_add_u32 s68, s47, 11534336
  s_waitcnt lgkmcnt(0)
  s_barrier
  ds_read_b32 v84, v189 offset:0
  ds_read_b32 v85, v189 offset:1024
  ds_read_b32 v86, v189 offset:2048
  ds_read_b32 v87, v189 offset:3072
  ds_read_b128 v[32:35], v169 offset:0
  ds_read_b128 v[36:39], v169 offset:4096
  ds_read_b128 v[40:43], v169 offset:8192
  ds_read_b128 v[44:47], v169 offset:12288
  ds_read_b128 v[48:51], v172 offset:16384
  ds_read_b128 v[52:55], v172 offset:20480
  ds_read_b128 v[56:59], v172 offset:24576
  ds_read_b128 v[60:63], v172 offset:28672
  ds_read_b128 v[64:67], v175 offset:32768
  ds_read_b128 v[68:71], v175 offset:36864
  ds_read_b128 v[72:75], v175 offset:40960
  ds_read_b128 v[76:79], v175 offset:45056
  s_waitcnt lgkmcnt(12)
  v_add_f32 v84, v84, v85
  v_add_f32 v86, v86, v87
  v_add_f32 v84, v84, v15
  v_add_f32 v84, v84, v86
  v_sub_f32 v84, 0, v84
  s_waitcnt lgkmcnt(8)
  v_pk_add_f32 v[16:17], v[16:17], v[32:33]
  v_pk_add_f32 v[18:19], v[18:19], v[34:35]
  v_pk_add_f32 v[20:21], v[20:21], v[36:37]
  v_pk_add_f32 v[22:23], v[22:23], v[38:39]
  v_pk_add_f32 v[24:25], v[24:25], v[40:41]
  v_pk_add_f32 v[26:27], v[26:27], v[42:43]
  v_pk_add_f32 v[28:29], v[28:29], v[44:45]
  v_pk_add_f32 v[30:31], v[30:31], v[46:47]
  s_waitcnt lgkmcnt(4)
  v_pk_add_f32 v[16:17], v[16:17], v[48:49]
  v_pk_add_f32 v[18:19], v[18:19], v[50:51]
  v_pk_add_f32 v[20:21], v[20:21], v[52:53]
  v_pk_add_f32 v[22:23], v[22:23], v[54:55]
  v_pk_add_f32 v[24:25], v[24:25], v[56:57]
  v_pk_add_f32 v[26:27], v[26:27], v[58:59]
  v_pk_add_f32 v[28:29], v[28:29], v[60:61]
  v_pk_add_f32 v[30:31], v[30:31], v[62:63]
  s_waitcnt lgkmcnt(0)
  v_pk_add_f32 v[16:17], v[16:17], v[64:65]
  v_pk_add_f32 v[18:19], v[18:19], v[66:67]
  v_pk_add_f32 v[20:21], v[20:21], v[68:69]
  v_pk_add_f32 v[22:23], v[22:23], v[70:71]
  v_pk_add_f32 v[24:25], v[24:25], v[72:73]
  v_pk_add_f32 v[26:27], v[26:27], v[74:75]
  v_pk_add_f32 v[28:29], v[28:29], v[76:77]
  v_pk_add_f32 v[30:31], v[30:31], v[78:79]
  v_cvt_pk_bf16_f32 v4, v16, v17
  v_cvt_pk_bf16_f32 v5, v18, v19
  v_cvt_pk_bf16_f32 v6, v20, v21
  v_cvt_pk_bf16_f32 v7, v22, v23
  v_cvt_pk_bf16_f32 v8, v24, v25
  v_cvt_pk_bf16_f32 v9, v26, v27
  v_cvt_pk_bf16_f32 v10, v28, v29
  v_cvt_pk_bf16_f32 v11, v30, v31
  v_pk_add_f32 v[16:17], v[16:17], v[84:85] op_sel_hi:[1,0]
  v_pk_add_f32 v[18:19], v[18:19], v[84:85] op_sel_hi:[1,0]
  v_pk_add_f32 v[20:21], v[20:21], v[84:85] op_sel_hi:[1,0]
  v_pk_add_f32 v[22:23], v[22:23], v[84:85] op_sel_hi:[1,0]
  v_pk_add_f32 v[24:25], v[24:25], v[84:85] op_sel_hi:[1,0]
  v_pk_add_f32 v[26:27], v[26:27], v[84:85] op_sel_hi:[1,0]
  v_pk_add_f32 v[28:29], v[28:29], v[84:85] op_sel_hi:[1,0]
  v_pk_add_f32 v[30:31], v[30:31], v[84:85] op_sel_hi:[1,0]
  v_cvt_pk_bf16_f32 v48, v16, v17
  v_cvt_pk_bf16_f32 v49, v18, v19
  v_cvt_pk_bf16_f32 v50, v20, v21
  v_cvt_pk_bf16_f32 v51, v22, v23
  v_cvt_pk_bf16_f32 v52, v24, v25
  v_cvt_pk_bf16_f32 v53, v26, v27
  v_cvt_pk_bf16_f32 v54, v28, v29
  v_cvt_pk_bf16_f32 v55, v30, v31
  buffer_store_dwordx4 v[48:51], v13, s[28:31], s66 offen sc1
  buffer_store_dwordx4 v[52:55], v13, s[28:31], s66 offen offset:512 sc1
  v_pk_mul_f32 v[32:33], v[16:17], v[16:17]
  v_pk_mul_f32 v[34:35], v[18:19], v[18:19]
  v_pk_fma_f32 v[32:33], v[20:21], v[20:21], v[32:33]
  v_pk_fma_f32 v[34:35], v[22:23], v[22:23], v[34:35]
  v_pk_fma_f32 v[32:33], v[24:25], v[24:25], v[32:33]
  v_pk_fma_f32 v[34:35], v[26:27], v[26:27], v[34:35]
  v_pk_fma_f32 v[32:33], v[28:29], v[28:29], v[32:33]
  v_pk_fma_f32 v[34:35], v[30:31], v[30:31], v[34:35]
  v_pk_add_f32 v[32:33], v[32:33], v[34:35]
  v_add_f32 v32, v32, v33
  v_mov_b32 v33, v32
  s_nop 1
  v_permlane32_swap_b32 v32, v33
  v_add_f32 v32, v32, v33
  v_lshlrev_b32 v34, 6, v1
  s_mov_b32 exec_hi, 0
  buffer_store_dword v32, v34, s[28:31], s68 offen
  s_mov_b32 exec_hi, -1
  s_waitcnt vmcnt(0)
  s_barrier
  v_and_b32 v177, 15, v0
  v_lshrrev_b32 v177, 2, v177
  v_bfe_u32 v178, v0, 4, 1
  v_lshl_add_u32 v177, v178, 2, v177
  v_lshl_add_u32 v177, v3, 4, v177
  v_mul_u32_u24 v177, 224, v177
  v_and_b32 v178, 3, v0
  v_lshl_add_u32 v168, v178, 3, v177
  v_add_u32 v169, 0x10000, v168
  v_add_u32 v170, 0x20000, v168
  v_and_b32 v177, 15, v0
  v_lshrrev_b32 v178, 4, v0
  v_lshlrev_b32 v178, 4, v178
  v_lshl_add_u32 v171, v177, 6, v178
  v_bfe_u32 v178, v0, 4, 1
  v_lshlrev_b32 v178, 5, v178
  v_lshl_add_u32 v178, v3, 4, v178
  v_add_u32 v178, v178, v177
  v_lshlrev_b32 v172, 4, v178
  s_lshr_b32 s47, s51, 5
  s_add_u32 s47, s47, s38
  s_lshl_b32 s66, s47, 15
  s_add_u32 s66, s66, 2097152
  s_mov_b32 s65, s66
  s_and_b32 s41, s36, 3
  s_lshl_b32 s41, s41, 12
  s_add_u32 s66, s65, s41
  s_add_u32 s67, s66, 16384
  s_lshl_b32 s68, s47, 11
  s_add_u32 s68, s68, 11534336
  s_waitcnt vmcnt(0)
  s_barrier
  buffer_load_dwordx4 a[0:3], v2, s[28:31], s66 offen offset:0 sc1
  buffer_load_dwordx4 a[4:7], v2, s[28:31], s67 offen offset:0 sc1
  buffer_load_dwordx4 a[8:11], v2, s[28:31], s66 offen offset:1024 sc1
  buffer_load_dwordx4 a[12:15], v2, s[28:31], s67 offen offset:1024 sc1
  buffer_load_dwordx4 a[16:19], v2, s[28:31], s66 offen offset:2048 sc1
  buffer_load_dwordx4 a[20:23], v2, s[28:31], s67 offen offset:2048 sc1
  ds_read_b64_tr_b16 v[128:129], v169 offset:0
  ds_read_b64_tr_b16 v[130:131], v169 offset:1792
  ds_read_b64_tr_b16 v[132:133], v169 offset:14464
  ds_read_b64_tr_b16 v[134:135], v169 offset:16256
  ds_read_b64_tr_b16 v[136:137], v169 offset:32
  ds_read_b64_tr_b16 v[138:139], v169 offset:1824
  ds_read_b64_tr_b16 v[140:141], v169 offset:14496
  ds_read_b64_tr_b16 v[142:143], v169 offset:16288
  ds_read_b64_tr_b16 v[144:145], v169 offset:64
  ds_read_b64_tr_b16 v[146:147], v169 offset:1856
  ds_read_b64_tr_b16 v[148:149], v169 offset:14528
  ds_read_b64_tr_b16 v[150:151], v169 offset:16320
  ds_read_b64_tr_b16 v[152:153], v169 offset:96
  ds_read_b64_tr_b16 v[154:155], v169 offset:1888
  s_waitcnt vmcnt(4)
  s_waitcnt lgkmcnt(12)
  v_mfma_f32_16x16x32_bf16 v[16:19], v[128:131], a[0:3], 0
  ds_read_b64_tr_b16 v[156:157], v169 offset:14560
  v_mfma_f32_16x16x32_bf16 v[20:23], v[128:131], a[4:7], 0
  ds_read_b64_tr_b16 v[158:159], v169 offset:16352
  s_waitcnt lgkmcnt(12)
  v_mfma_f32_16x16x32_bf16 v[24:27], v[132:135], a[0:3], 0
  ds_read_b64_tr_b16 v[160:161], v169 offset:128
  v_mfma_f32_16x16x32_bf16 v[28:31], v[132:135], a[4:7], 0
  ds_read_b64_tr_b16 v[162:163], v169 offset:1920
  buffer_load_dwordx4 a[24:27], v2, s[28:31], s66 offen offset:3072 sc1
  s_waitcnt lgkmcnt(12)
  v_mfma_f32_16x16x32_bf16 v[32:35], v[136:139], a[0:3], 0
  ds_read_b64_tr_b16 v[164:165], v169 offset:14592
  v_mfma_f32_16x16x32_bf16 v[36:39], v[136:139], a[4:7], 0
  ds_read_b64_tr_b16 v[166:167], v169 offset:16384
  s_waitcnt lgkmcnt(12)
  v_mfma_f32_16x16x32_bf16 v[40:43], v[140:143], a[0:3], 0
  ds_read_b64_tr_b16 v[128:129], v169 offset:160
  v_mfma_f32_16x16x32_bf16 v[44:47], v[140:143], a[4:7], 0
  ds_read_b64_tr_b16 v[130:131], v169 offset:1952
  s_waitcnt lgkmcnt(12)
  v_mfma_f32_16x16x32_bf16 v[48:51], v[144:147], a[0:3], 0
  ds_read_b64_tr_b16 v[132:133], v169 offset:14624
  v_mfma_f32_16x16x32_bf16 v[52:55], v[144:147], a[4:7], 0
  ds_read_b64_tr_b16 v[134:135], v169 offset:16416
  buffer_load_dwordx4 a[28:31], v2, s[28:31], s67 offen offset:3072 sc1
  s_waitcnt lgkmcnt(12)
  v_mfma_f32_16x16x32_bf16 v[56:59], v[148:151], a[0:3], 0
  ds_read_b64_tr_b16 v[136:137], v169 offset:192
  v_mfma_f32_16x16x32_bf16 v[60:63], v[148:151], a[4:7], 0
  ds_read_b64_tr_b16 v[138:139], v169 offset:1984
  s_waitcnt lgkmcnt(12)
  v_mfma_f32_16x16x32_bf16 v[64:67], v[152:155], a[0:3], 0
  ds_read_b64_tr_b16 v[140:141], v169 offset:14656
  v_mfma_f32_16x16x32_bf16 v[68:71], v[152:155], a[4:7], 0
  ds_read_b64_tr_b16 v[142:143], v169 offset:16448
  s_waitcnt lgkmcnt(12)
  v_mfma_f32_16x16x32_bf16 v[72:75], v[156:159], a[0:3], 0
  ds_read_b64_tr_b16 v[144:145], v169 offset:7168
  v_mfma_f32_16x16x32_bf16 v[76:79], v[156:159], a[4:7], 0
  ds_read_b64_tr_b16 v[146:147], v169 offset:8960
  s_waitcnt lgkmcnt(12)
  v_mfma_f32_16x16x32_bf16 v[80:83], v[160:163], a[0:3], 0
  ds_read_b64_tr_b16 v[148:149], v169 offset:21632
  v_mfma_f32_16x16x32_bf16 v[84:87], v[160:163], a[4:7], 0
  ds_read_b64_tr_b16 v[150:151], v169 offset:23424
  s_add_u32 s41, s41, 4096
  s_and_b32 s41, s41, 0x3fff
  s_add_u32 s66, s65, s41
  s_add_u32 s67, s66, 16384
  buffer_load_dwordx4 a[32:35], v2, s[28:31], s66 offen offset:0 sc1
  s_waitcnt lgkmcnt(12)
  v_mfma_f32_16x16x32_bf16 v[88:91], v[164:167], a[0:3], 0
  ds_read_b64_tr_b16 v[152:153], v169 offset:7200
  v_mfma_f32_16x16x32_bf16 v[92:95], v[164:167], a[4:7], 0
  ds_read_b64_tr_b16 v[154:155], v169 offset:8992
  s_waitcnt lgkmcnt(12)
  v_mfma_f32_16x16x32_bf16 v[96:99], v[128:131], a[0:3], 0
  ds_read_b64_tr_b16 v[156:157], v169 offset:21664
  v_mfma_f32_16x16x32_bf16 v[100:103], v[128:131], a[4:7], 0
  ds_read_b64_tr_b16 v[158:159], v169 offset:23456
  s_waitcnt lgkmcnt(12)
  v_mfma_f32_16x16x32_bf16 v[104:107], v[132:135], a[0:3], 0
  ds_read_b64_tr_b16 v[160:161], v169 offset:7232
  v_mfma_f32_16x16x32_bf16 v[108:111], v[132:135], a[4:7], 0
  ds_read_b64_tr_b16 v[162:163], v169 offset:9024
  buffer_load_dwordx4 a[36:39], v2, s[28:31], s67 offen offset:0 sc1
  s_waitcnt lgkmcnt(12)
  v_mfma_f32_16x16x32_bf16 v[112:115], v[136:139], a[0:3], 0
  ds_read_b64_tr_b16 v[164:165], v169 offset:21696
  v_mfma_f32_16x16x32_bf16 v[116:119], v[136:139], a[4:7], 0
  ds_read_b64_tr_b16 v[166:167], v169 offset:23488
  s_waitcnt lgkmcnt(12)
  v_mfma_f32_16x16x32_bf16 v[120:123], v[140:143], a[0:3], 0
  ds_read_b64_tr_b16 v[128:129], v169 offset:7264
  v_mfma_f32_16x16x32_bf16 v[124:127], v[140:143], a[4:7], 0
  ds_read_b64_tr_b16 v[130:131], v169 offset:9056
  s_waitcnt vmcnt(6)
  s_waitcnt lgkmcnt(12)
  v_mfma_f32_16x16x32_bf16 v[16:19], v[144:147], a[8:11], v[16:19]
  ds_read_b64_tr_b16 v[132:133], v169 offset:21728
  v_mfma_f32_16x16x32_bf16 v[20:23], v[144:147], a[12:15], v[20:23]
  ds_read_b64_tr_b16 v[134:135], v169 offset:23520
  s_waitcnt lgkmcnt(12)
  v_mfma_f32_16x16x32_bf16 v[24:27], v[148:151], a[8:11], v[24:27]
  ds_read_b64_tr_b16 v[136:137], v169 offset:7296
  v_mfma_f32_16x16x32_bf16 v[28:31], v[148:151], a[12:15], v[28:31]
  ds_read_b64_tr_b16 v[138:139], v169 offset:9088
  buffer_load_dwordx4 a[40:43], v2, s[28:31], s66 offen offset:1024 sc1
  s_waitcnt lgkmcnt(12)
  v_mfma_f32_16x16x32_bf16 v[32:35], v[152:155], a[8:11], v[32:35]
  ds_read_b64_tr_b16 v[140:141], v169 offset:21760
  v_mfma_f32_16x16x32_bf16 v[36:39], v[152:155], a[12:15], v[36:39]
  ds_read_b64_tr_b16 v[142:143], v169 offset:23552
  s_waitcnt lgkmcnt(12)
  v_mfma_f32_16x16x32_bf16 v[40:43], v[156:159], a[8:11], v[40:43]
  ds_read_b64_tr_b16 v[144:145], v169 offset:7328
  v_mfma_f32_16x16x32_bf16 v[44:47], v[156:159], a[12:15], v[44:47]
  ds_read_b64_tr_b16 v[146:147], v169 offset:9120
  s_waitcnt lgkmcnt(12)
  v_mfma_f32_16x16x32_bf16 v[48:51], v[160:163], a[8:11], v[48:51]
  ds_read_b64_tr_b16 v[148:149], v169 offset:21792
  v_mfma_f32_16x16x32_bf16 v[52:55], v[160:163], a[12:15], v[52:55]
  ds_read_b64_tr_b16 v[150:151], v169 offset:23584
  buffer_load_dwordx4 a[44:47], v2, s[28:31], s67 offen offset:1024 sc1
  s_waitcnt lgkmcnt(12)
  v_mfma_f32_16x16x32_bf16 v[56:59], v[164:167], a[8:11], v[56:59]
  ds_read_b64_tr_b16 v[152:153], v169 offset:7360
  v_mfma_f32_16x16x32_bf16 v[60:63], v[164:167], a[12:15], v[60:63]
  ds_read_b64_tr_b16 v[154:155], v169 offset:9152
  s_waitcnt lgkmcnt(12)
  v_mfma_f32_16x16x32_bf16 v[64:67], v[128:131], a[8:11], v[64:67]
  ds_read_b64_tr_b16 v[156:157], v169 offset:21824
  v_mfma_f32_16x16x32_bf16 v[68:71], v[128:131], a[12:15], v[68:71]
  ds_read_b64_tr_b16 v[158:159], v169 offset:23616
  s_barrier
  s_waitcnt lgkmcnt(12)
  v_mfma_f32_16x16x32_bf16 v[72:75], v[132:135], a[8:11], v[72:75]
  ds_read_b64_tr_b16 v[160:161], v169 offset:28800
  v_mfma_f32_16x16x32_bf16 v[76:79], v[132:135], a[12:15], v[76:79]
  ds_read_b64_tr_b16 v[162:163], v169 offset:30592
  s_waitcnt lgkmcnt(12)
  v_mfma_f32_16x16x32_bf16 v[80:83], v[136:139], a[8:11], v[80:83]
  ds_read_b64_tr_b16 v[164:165], v169 offset:43264
  v_mfma_f32_16x16x32_bf16 v[84:87], v[136:139], a[12:15], v[84:87]
  ds_read_b64_tr_b16 v[166:167], v169 offset:45056
  buffer_load_dwordx4 a[48:51], v2, s[28:31], s66 offen offset:2048 sc1
  s_waitcnt lgkmcnt(12)
  v_mfma_f32_16x16x32_bf16 v[88:91], v[140:143], a[8:11], v[88:91]
  ds_read_b64_tr_b16 v[128:129], v169 offset:28832
  v_mfma_f32_16x16x32_bf16 v[92:95], v[140:143], a[12:15], v[92:95]
  ds_read_b64_tr_b16 v[130:131], v169 offset:30624
  s_waitcnt lgkmcnt(12)
  v_mfma_f32_16x16x32_bf16 v[96:99], v[144:147], a[8:11], v[96:99]
  ds_read_b64_tr_b16 v[132:133], v169 offset:43296
  v_mfma_f32_16x16x32_bf16 v[100:103], v[144:147], a[12:15], v[100:103]
  ds_read_b64_tr_b16 v[134:135], v169 offset:45088
  s_waitcnt lgkmcnt(12)
  v_mfma_f32_16x16x32_bf16 v[104:107], v[148:151], a[8:11], v[104:107]
  ds_read_b64_tr_b16 v[136:137], v169 offset:28864
  v_mfma_f32_16x16x32_bf16 v[108:111], v[148:151], a[12:15], v[108:111]
  ds_read_b64_tr_b16 v[138:139], v169 offset:30656
  buffer_load_dwordx4 a[52:55], v2, s[28:31], s67 offen offset:2048 sc1
  s_waitcnt lgkmcnt(12)
  v_mfma_f32_16x16x32_bf16 v[112:115], v[152:155], a[8:11], v[112:115]
  ds_read_b64_tr_b16 v[140:141], v169 offset:43328
  v_mfma_f32_16x16x32_bf16 v[116:119], v[152:155], a[12:15], v[116:119]
  ds_read_b64_tr_b16 v[142:143], v169 offset:45120
  s_waitcnt lgkmcnt(12)
  v_mfma_f32_16x16x32_bf16 v[120:123], v[156:159], a[8:11], v[120:123]
  ds_read_b64_tr_b16 v[144:145], v169 offset:28896
  v_mfma_f32_16x16x32_bf16 v[124:127], v[156:159], a[12:15], v[124:127]
  ds_read_b64_tr_b16 v[146:147], v169 offset:30688
  s_waitcnt vmcnt(8)
  s_waitcnt lgkmcnt(12)
  v_mfma_f32_16x16x32_bf16 v[16:19], v[160:163], a[16:19], v[16:19]
  ds_read_b64_tr_b16 v[148:149], v169 offset:43360
  v_mfma_f32_16x16x32_bf16 v[20:23], v[160:163], a[20:23], v[20:23]
  ds_read_b64_tr_b16 v[150:151], v169 offset:45152
  s_waitcnt lgkmcnt(12)
  v_mfma_f32_16x16x32_bf16 v[24:27], v[164:167], a[16:19], v[24:27]
  ds_read_b64_tr_b16 v[152:153], v169 offset:28928
  v_mfma_f32_16x16x32_bf16 v[28:31], v[164:167], a[20:23], v[28:31]
  ds_read_b64_tr_b16 v[154:155], v169 offset:30720
  buffer_load_dwordx4 a[56:59], v2, s[28:31], s66 offen offset:3072 sc1
  s_waitcnt lgkmcnt(12)
  v_mfma_f32_16x16x32_bf16 v[32:35], v[128:131], a[16:19], v[32:35]
  ds_read_b64_tr_b16 v[156:157], v169 offset:43392
  v_mfma_f32_16x16x32_bf16 v[36:39], v[128:131], a[20:23], v[36:39]
  ds_read_b64_tr_b16 v[158:159], v169 offset:45184
  s_waitcnt lgkmcnt(12)
  v_mfma_f32_16x16x32_bf16 v[40:43], v[132:135], a[16:19], v[40:43]
  ds_read_b64_tr_b16 v[160:161], v169 offset:28960
  v_mfma_f32_16x16x32_bf16 v[44:47], v[132:135], a[20:23], v[44:47]
  ds_read_b64_tr_b16 v[162:163], v169 offset:30752
  s_waitcnt lgkmcnt(12)
  v_mfma_f32_16x16x32_bf16 v[48:51], v[136:139], a[16:19], v[48:51]
  ds_read_b64_tr_b16 v[164:165], v169 offset:43424
  v_mfma_f32_16x16x32_bf16 v[52:55], v[136:139], a[20:23], v[52:55]
  ds_read_b64_tr_b16 v[166:167], v169 offset:45216
  buffer_load_dwordx4 a[60:63], v2, s[28:31], s67 offen offset:3072 sc1
  s_waitcnt lgkmcnt(12)
  v_mfma_f32_16x16x32_bf16 v[56:59], v[140:143], a[16:19], v[56:59]
  ds_read_b64_tr_b16 v[128:129], v169 offset:28992
  v_mfma_f32_16x16x32_bf16 v[60:63], v[140:143], a[20:23], v[60:63]
  ds_read_b64_tr_b16 v[130:131], v169 offset:30784
  s_waitcnt lgkmcnt(12)
  v_mfma_f32_16x16x32_bf16 v[64:67], v[144:147], a[16:19], v[64:67]
  ds_read_b64_tr_b16 v[132:133], v169 offset:43456
  v_mfma_f32_16x16x32_bf16 v[68:71], v[144:147], a[20:23], v[68:71]
  ds_read_b64_tr_b16 v[134:135], v169 offset:45248
  s_waitcnt lgkmcnt(12)
  v_mfma_f32_16x16x32_bf16 v[72:75], v[148:151], a[16:19], v[72:75]
  ds_read_b64_tr_b16 v[136:137], v169 offset:35968
  v_mfma_f32_16x16x32_bf16 v[76:79], v[148:151], a[20:23], v[76:79]
  ds_read_b64_tr_b16 v[138:139], v169 offset:37760
  s_waitcnt lgkmcnt(12)
  v_mfma_f32_16x16x32_bf16 v[80:83], v[152:155], a[16:19], v[80:83]
  ds_read_b64_tr_b16 v[140:141], v169 offset:50432
  v_mfma_f32_16x16x32_bf16 v[84:87], v[152:155], a[20:23], v[84:87]
  ds_read_b64_tr_b16 v[142:143], v169 offset:52224
  s_waitcnt lgkmcnt(12)
  v_mfma_f32_16x16x32_bf16 v[88:91], v[156:159], a[16:19], v[88:91]
  ds_read_b64_tr_b16 v[144:145], v169 offset:36000
  v_mfma_f32_16x16x32_bf16 v[92:95], v[156:159], a[20:23], v[92:95]
  ds_read_b64_tr_b16 v[146:147], v169 offset:37792
  s_waitcnt lgkmcnt(12)
  v_mfma_f32_16x16x32_bf16 v[96:99], v[160:163], a[16:19], v[96:99]
  ds_read_b64_tr_b16 v[148:149], v169 offset:50464
  v_mfma_f32_16x16x32_bf16 v[100:103], v[160:163], a[20:23], v[100:103]
  ds_read_b64_tr_b16 v[150:151], v169 offset:52256
  s_waitcnt lgkmcnt(12)
  v_mfma_f32_16x16x32_bf16 v[104:107], v[164:167], a[16:19], v[104:107]
  ds_read_b64_tr_b16 v[152:153], v169 offset:36032
  v_mfma_f32_16x16x32_bf16 v[108:111], v[164:167], a[20:23], v[108:111]
  ds_read_b64_tr_b16 v[154:155], v169 offset:37824
  s_waitcnt lgkmcnt(12)
  v_mfma_f32_16x16x32_bf16 v[112:115], v[128:131], a[16:19], v[112:115]
  ds_read_b64_tr_b16 v[156:157], v169 offset:50496
  v_mfma_f32_16x16x32_bf16 v[116:119], v[128:131], a[20:23], v[116:119]
  ds_read_b64_tr_b16 v[158:159], v169 offset:52288
  s_waitcnt lgkmcnt(12)
  v_mfma_f32_16x16x32_bf16 v[120:123], v[132:135], a[16:19], v[120:123]
  ds_read_b64_tr_b16 v[160:161], v169 offset:36064
  v_mfma_f32_16x16x32_bf16 v[124:127], v[132:135], a[20:23], v[124:127]
  ds_read_b64_tr_b16 v[162:163], v169 offset:37856
  s_waitcnt vmcnt(8)
  s_waitcnt lgkmcnt(12)
  v_mfma_f32_16x16x32_bf16 v[16:19], v[136:139], a[24:27], v[16:19]
  ds_read_b64_tr_b16 v[164:165], v169 offset:50528
  v_mfma_f32_16x16x32_bf16 v[20:23], v[136:139], a[28:31], v[20:23]
  ds_read_b64_tr_b16 v[166:167], v169 offset:52320
  s_waitcnt lgkmcnt(12)
  v_mfma_f32_16x16x32_bf16 v[24:27], v[140:143], a[24:27], v[24:27]
  ds_read_b64_tr_b16 v[128:129], v169 offset:36096
  v_mfma_f32_16x16x32_bf16 v[28:31], v[140:143], a[28:31], v[28:31]
  ds_read_b64_tr_b16 v[130:131], v169 offset:37888
  s_add_u32 s41, s41, 4096
  s_and_b32 s41, s41, 0x3fff
  s_add_u32 s66, s65, s41
  s_add_u32 s67, s66, 16384
  buffer_load_dwordx4 a[0:3], v2, s[28:31], s66 offen offset:0 sc1
  s_waitcnt lgkmcnt(12)
  v_mfma_f32_16x16x32_bf16 v[32:35], v[144:147], a[24:27], v[32:35]
  ds_read_b64_tr_b16 v[132:133], v169 offset:50560
  v_mfma_f32_16x16x32_bf16 v[36:39], v[144:147], a[28:31], v[36:39]
  ds_read_b64_tr_b16 v[134:135], v169 offset:52352
  s_waitcnt lgkmcnt(12)
  v_mfma_f32_16x16x32_bf16 v[40:43], v[148:151], a[24:27], v[40:43]
  ds_read_b64_tr_b16 v[136:137], v169 offset:36128
  v_mfma_f32_16x16x32_bf16 v[44:47], v[148:151], a[28:31], v[44:47]
  ds_read_b64_tr_b16 v[138:139], v169 offset:37920
  s_waitcnt lgkmcnt(12)
  v_mfma_f32_16x16x32_bf16 v[48:51], v[152:155], a[24:27], v[48:51]
  ds_read_b64_tr_b16 v[140:141], v169 offset:50592
  v_mfma_f32_16x16x32_bf16 v[52:55], v[152:155], a[28:31], v[52:55]
  ds_read_b64_tr_b16 v[142:143], v169 offset:52384
  buffer_load_dwordx4 a[4:7], v2, s[28:31], s67 offen offset:0 sc1
  s_waitcnt lgkmcnt(12)
  v_mfma_f32_16x16x32_bf16 v[56:59], v[156:159], a[24:27], v[56:59]
  ds_read_b64_tr_b16 v[144:145], v169 offset:36160
  v_mfma_f32_16x16x32_bf16 v[60:63], v[156:159], a[28:31], v[60:63]
  ds_read_b64_tr_b16 v[146:147], v169 offset:37952
  s_waitcnt lgkmcnt(12)
  v_mfma_f32_16x16x32_bf16 v[64:67], v[160:163], a[24:27], v[64:67]
  ds_read_b64_tr_b16 v[148:149], v169 offset:50624
  v_mfma_f32_16x16x32_bf16 v[68:71], v[160:163], a[28:31], v[68:71]
  ds_read_b64_tr_b16 v[150:151], v169 offset:52416
  s_barrier
  s_waitcnt lgkmcnt(12)
  v_mfma_f32_16x16x32_bf16 v[72:75], v[164:167], a[24:27], v[72:75]
  ds_read_b64_tr_b16 v[152:153], v169 offset:57600
  v_mfma_f32_16x16x32_bf16 v[76:79], v[164:167], a[28:31], v[76:79]
  ds_read_b64_tr_b16 v[154:155], v169 offset:59392
  s_waitcnt lgkmcnt(12)
  v_mfma_f32_16x16x32_bf16 v[80:83], v[128:131], a[24:27], v[80:83]
  ds_read_b64_tr_b16 v[156:157], v170 offset:6528
  v_mfma_f32_16x16x32_bf16 v[84:87], v[128:131], a[28:31], v[84:87]
  ds_read_b64_tr_b16 v[158:159], v170 offset:8320
  s_waitcnt lgkmcnt(12)
  v_mfma_f32_16x16x32_bf16 v[88:91], v[132:135], a[24:27], v[88:91]
  ds_read_b64_tr_b16 v[160:161], v169 offset:57632
  v_mfma_f32_16x16x32_bf16 v[92:95], v[132:135], a[28:31], v[92:95]
  ds_read_b64_tr_b16 v[162:163], v169 offset:59424
  s_waitcnt lgkmcnt(12)
  v_mfma_f32_16x16x32_bf16 v[96:99], v[136:139], a[24:27], v[96:99]
  ds_read_b64_tr_b16 v[164:165], v170 offset:6560
  v_mfma_f32_16x16x32_bf16 v[100:103], v[136:139], a[28:31], v[100:103]
  ds_read_b64_tr_b16 v[166:167], v170 offset:8352
  s_waitcnt lgkmcnt(12)
  v_mfma_f32_16x16x32_bf16 v[104:107], v[140:143], a[24:27], v[104:107]
  ds_read_b64_tr_b16 v[128:129], v169 offset:57664
  v_mfma_f32_16x16x32_bf16 v[108:111], v[140:143], a[28:31], v[108:111]
  ds_read_b64_tr_b16 v[130:131], v169 offset:59456
  s_waitcnt lgkmcnt(12)
  v_mfma_f32_16x16x32_bf16 v[112:115], v[144:147], a[24:27], v[112:115]
  ds_read_b64_tr_b16 v[132:133], v170 offset:6592
  v_mfma_f32_16x16x32_bf16 v[116:119], v[144:147], a[28:31], v[116:119]
  ds_read_b64_tr_b16 v[134:135], v170 offset:8384
  s_waitcnt lgkmcnt(12)
  v_mfma_f32_16x16x32_bf16 v[120:123], v[148:151], a[24:27], v[120:123]
  ds_read_b64_tr_b16 v[136:137], v169 offset:57696
  v_mfma_f32_16x16x32_bf16 v[124:127], v[148:151], a[28:31], v[124:127]
  ds_read_b64_tr_b16 v[138:139], v169 offset:59488
  s_waitcnt vmcnt(8)
  s_waitcnt lgkmcnt(12)
  v_mfma_f32_16x16x32_bf16 v[16:19], v[152:155], a[32:35], v[16:19]
  ds_read_b64_tr_b16 v[140:141], v170 offset:6624
  v_mfma_f32_16x16x32_bf16 v[20:23], v[152:155], a[36:39], v[20:23]
  ds_read_b64_tr_b16 v[142:143], v170 offset:8416
  s_waitcnt lgkmcnt(12)
  v_mfma_f32_16x16x32_bf16 v[24:27], v[156:159], a[32:35], v[24:27]
  ds_read_b64_tr_b16 v[144:145], v169 offset:57728
  v_mfma_f32_16x16x32_bf16 v[28:31], v[156:159], a[36:39], v[28:31]
  ds_read_b64_tr_b16 v[146:147], v169 offset:59520
  buffer_load_dwordx4 a[8:11], v2, s[28:31], s66 offen offset:1024 sc1
  s_waitcnt lgkmcnt(12)
  v_mfma_f32_16x16x32_bf16 v[32:35], v[160:163], a[32:35], v[32:35]
  ds_read_b64_tr_b16 v[148:149], v170 offset:6656
  v_mfma_f32_16x16x32_bf16 v[36:39], v[160:163], a[36:39], v[36:39]
  ds_read_b64_tr_b16 v[150:151], v170 offset:8448
  s_waitcnt lgkmcnt(12)
  v_mfma_f32_16x16x32_bf16 v[40:43], v[164:167], a[32:35], v[40:43]
  ds_read_b64_tr_b16 v[152:153], v169 offset:57760
  v_mfma_f32_16x16x32_bf16 v[44:47], v[164:167], a[36:39], v[44:47]
  ds_read_b64_tr_b16 v[154:155], v169 offset:59552
  s_waitcnt lgkmcnt(12)
  v_mfma_f32_16x16x32_bf16 v[48:51], v[128:131], a[32:35], v[48:51]
  ds_read_b64_tr_b16 v[156:157], v170 offset:6688
  v_mfma_f32_16x16x32_bf16 v[52:55], v[128:131], a[36:39], v[52:55]
  ds_read_b64_tr_b16 v[158:159], v170 offset:8480
  s_waitcnt lgkmcnt(12)
  v_mfma_f32_16x16x32_bf16 v[56:59], v[132:135], a[32:35], v[56:59]
  ds_read_b64_tr_b16 v[160:161], v169 offset:57792
  v_mfma_f32_16x16x32_bf16 v[60:63], v[132:135], a[36:39], v[60:63]
  ds_read_b64_tr_b16 v[162:163], v169 offset:59584
  s_waitcnt lgkmcnt(12)
  v_mfma_f32_16x16x32_bf16 v[64:67], v[136:139], a[32:35], v[64:67]
  ds_read_b64_tr_b16 v[164:165], v170 offset:6720
  v_mfma_f32_16x16x32_bf16 v[68:71], v[136:139], a[36:39], v[68:71]
  ds_read_b64_tr_b16 v[166:167], v170 offset:8512
  s_waitcnt lgkmcnt(12)
  v_mfma_f32_16x16x32_bf16 v[72:75], v[140:143], a[32:35], v[72:75]
  ds_read_b64_tr_b16 v[128:129], v169 offset:64768
  v_mfma_f32_16x16x32_bf16 v[76:79], v[140:143], a[36:39], v[76:79]
  ds_read_b64_tr_b16 v[130:131], v170 offset:1024
  s_waitcnt lgkmcnt(12)
  v_mfma_f32_16x16x32_bf16 v[80:83], v[144:147], a[32:35], v[80:83]
  ds_read_b64_tr_b16 v[132:133], v170 offset:13696
  v_mfma_f32_16x16x32_bf16 v[84:87], v[144:147], a[36:39], v[84:87]
  ds_read_b64_tr_b16 v[134:135], v170 offset:15488
  buffer_load_dwordx4 a[12:15], v2, s[28:31], s67 offen offset:1024 sc1
  s_waitcnt lgkmcnt(12)
  v_mfma_f32_16x16x32_bf16 v[88:91], v[148:151], a[32:35], v[88:91]
  ds_read_b64_tr_b16 v[136:137], v169 offset:64800
  v_mfma_f32_16x16x32_bf16 v[92:95], v[148:151], a[36:39], v[92:95]
  ds_read_b64_tr_b16 v[138:139], v170 offset:1056
  s_waitcnt lgkmcnt(12)
  v_mfma_f32_16x16x32_bf16 v[96:99], v[152:155], a[32:35], v[96:99]
  ds_read_b64_tr_b16 v[140:141], v170 offset:13728
  v_mfma_f32_16x16x32_bf16 v[100:103], v[152:155], a[36:39], v[100:103]
  ds_read_b64_tr_b16 v[142:143], v170 offset:15520
  s_waitcnt lgkmcnt(12)
  v_mfma_f32_16x16x32_bf16 v[104:107], v[156:159], a[32:35], v[104:107]
  ds_read_b64_tr_b16 v[144:145], v169 offset:64832
  v_mfma_f32_16x16x32_bf16 v[108:111], v[156:159], a[36:39], v[108:111]
  ds_read_b64_tr_b16 v[146:147], v170 offset:1088
  s_waitcnt lgkmcnt(12)
  v_mfma_f32_16x16x32_bf16 v[112:115], v[160:163], a[32:35], v[112:115]
  ds_read_b64_tr_b16 v[148:149], v170 offset:13760
  v_mfma_f32_16x16x32_bf16 v[116:119], v[160:163], a[36:39], v[116:119]
  ds_read_b64_tr_b16 v[150:151], v170 offset:15552
  s_waitcnt lgkmcnt(12)
  v_mfma_f32_16x16x32_bf16 v[120:123], v[164:167], a[32:35], v[120:123]
  ds_read_b64_tr_b16 v[152:153], v169 offset:64864
  v_mfma_f32_16x16x32_bf16 v[124:127], v[164:167], a[36:39], v[124:127]
  ds_read_b64_tr_b16 v[154:155], v170 offset:1120
  s_waitcnt vmcnt(8)
  s_waitcnt lgkmcnt(12)
  v_mfma_f32_16x16x32_bf16 v[16:19], v[128:131], a[40:43], v[16:19]
  ds_read_b64_tr_b16 v[156:157], v170 offset:13792
  v_mfma_f32_16x16x32_bf16 v[20:23], v[128:131], a[44:47], v[20:23]
  ds_read_b64_tr_b16 v[158:159], v170 offset:15584
  s_waitcnt lgkmcnt(12)
  v_mfma_f32_16x16x32_bf16 v[24:27], v[132:135], a[40:43], v[24:27]
  ds_read_b64_tr_b16 v[160:161], v169 offset:64896
  v_mfma_f32_16x16x32_bf16 v[28:31], v[132:135], a[44:47], v[28:31]
  ds_read_b64_tr_b16 v[162:163], v170 offset:1152
  buffer_load_dwordx4 a[16:19], v2, s[28:31], s66 offen offset:2048 sc1
  s_waitcnt lgkmcnt(12)
  v_mfma_f32_16x16x32_bf16 v[32:35], v[136:139], a[40:43], v[32:35]
  ds_read_b64_tr_b16 v[164:165], v170 offset:13824
  v_mfma_f32_16x16x32_bf16 v[36:39], v[136:139], a[44:47], v[36:39]
  ds_read_b64_tr_b16 v[166:167], v170 offset:15616
  s_waitcnt lgkmcnt(12)
  v_mfma_f32_16x16x32_bf16 v[40:43], v[140:143], a[40:43], v[40:43]
  ds_read_b64_tr_b16 v[128:129], v169 offset:64928
  v_mfma_f32_16x16x32_bf16 v[44:47], v[140:143], a[44:47], v[44:47]
  ds_read_b64_tr_b16 v[130:131], v170 offset:1184
  s_waitcnt lgkmcnt(12)
  v_mfma_f32_16x16x32_bf16 v[48:51], v[144:147], a[40:43], v[48:51]
  ds_read_b64_tr_b16 v[132:133], v170 offset:13856
  v_mfma_f32_16x16x32_bf16 v[52:55], v[144:147], a[44:47], v[52:55]
  ds_read_b64_tr_b16 v[134:135], v170 offset:15648
  s_waitcnt lgkmcnt(12)
  v_mfma_f32_16x16x32_bf16 v[56:59], v[148:151], a[40:43], v[56:59]
  ds_read_b64_tr_b16 v[136:137], v169 offset:64960
  v_mfma_f32_16x16x32_bf16 v[60:63], v[148:151], a[44:47], v[60:63]
  ds_read_b64_tr_b16 v[138:139], v170 offset:1216
  s_waitcnt lgkmcnt(12)
  v_mfma_f32_16x16x32_bf16 v[64:67], v[152:155], a[40:43], v[64:67]
  ds_read_b64_tr_b16 v[140:141], v170 offset:13888
  v_mfma_f32_16x16x32_bf16 v[68:71], v[152:155], a[44:47], v[68:71]
  ds_read_b64_tr_b16 v[142:143], v170 offset:15680
  s_barrier
  s_waitcnt lgkmcnt(12)
  v_mfma_f32_16x16x32_bf16 v[72:75], v[156:159], a[40:43], v[72:75]
  ds_read_b64_tr_b16 v[144:145], v168 offset:0
  v_mfma_f32_16x16x32_bf16 v[76:79], v[156:159], a[44:47], v[76:79]
  ds_read_b64_tr_b16 v[146:147], v168 offset:1792
  s_waitcnt lgkmcnt(12)
  v_mfma_f32_16x16x32_bf16 v[80:83], v[160:163], a[40:43], v[80:83]
  ds_read_b64_tr_b16 v[148:149], v168 offset:14464
  v_mfma_f32_16x16x32_bf16 v[84:87], v[160:163], a[44:47], v[84:87]
  ds_read_b64_tr_b16 v[150:151], v168 offset:16256
  buffer_load_dwordx4 a[20:23], v2, s[28:31], s67 offen offset:2048 sc1
  s_waitcnt lgkmcnt(12)
  v_mfma_f32_16x16x32_bf16 v[88:91], v[164:167], a[40:43], v[88:91]
  ds_read_b64_tr_b16 v[152:153], v168 offset:32
  v_mfma_f32_16x16x32_bf16 v[92:95], v[164:167], a[44:47], v[92:95]
  ds_read_b64_tr_b16 v[154:155], v168 offset:1824
  s_waitcnt lgkmcnt(12)
  v_mfma_f32_16x16x32_bf16 v[96:99], v[128:131], a[40:43], v[96:99]
  ds_read_b64_tr_b16 v[156:157], v168 offset:14496
  v_mfma_f32_16x16x32_bf16 v[100:103], v[128:131], a[44:47], v[100:103]
  ds_read_b64_tr_b16 v[158:159], v168 offset:16288
  s_waitcnt lgkmcnt(12)
  v_mfma_f32_16x16x32_bf16 v[104:107], v[132:135], a[40:43], v[104:107]
  ds_read_b64_tr_b16 v[160:161], v168 offset:64
  v_mfma_f32_16x16x32_bf16 v[108:111], v[132:135], a[44:47], v[108:111]
  ds_read_b64_tr_b16 v[162:163], v168 offset:1856
  s_waitcnt lgkmcnt(12)
  v_mfma_f32_16x16x32_bf16 v[112:115], v[136:139], a[40:43], v[112:115]
  ds_read_b64_tr_b16 v[164:165], v168 offset:14528
  v_mfma_f32_16x16x32_bf16 v[116:119], v[136:139], a[44:47], v[116:119]
  ds_read_b64_tr_b16 v[166:167], v168 offset:16320
  s_waitcnt lgkmcnt(12)
  v_mfma_f32_16x16x32_bf16 v[120:123], v[140:143], a[40:43], v[120:123]
  ds_read_b64_tr_b16 v[128:129], v168 offset:96
  v_mfma_f32_16x16x32_bf16 v[124:127], v[140:143], a[44:47], v[124:127]
  ds_read_b64_tr_b16 v[130:131], v168 offset:1888
  s_waitcnt vmcnt(8)
  s_waitcnt lgkmcnt(12)
  v_mfma_f32_16x16x32_bf16 v[16:19], v[144:147], a[48:51], v[16:19]
  ds_read_b64_tr_b16 v[132:133], v168 offset:14560
  v_mfma_f32_16x16x32_bf16 v[20:23], v[144:147], a[52:55], v[20:23]
  ds_read_b64_tr_b16 v[134:135], v168 offset:16352
  s_waitcnt lgkmcnt(12)
  v_mfma_f32_16x16x32_bf16 v[24:27], v[148:151], a[48:51], v[24:27]
  ds_read_b64_tr_b16 v[136:137], v168 offset:128
  v_mfma_f32_16x16x32_bf16 v[28:31], v[148:151], a[52:55], v[28:31]
  ds_read_b64_tr_b16 v[138:139], v168 offset:1920
  buffer_load_dwordx4 a[24:27], v2, s[28:31], s66 offen offset:3072 sc1
  s_waitcnt lgkmcnt(12)
  v_mfma_f32_16x16x32_bf16 v[32:35], v[152:155], a[48:51], v[32:35]
  ds_read_b64_tr_b16 v[140:141], v168 offset:14592
  v_mfma_f32_16x16x32_bf16 v[36:39], v[152:155], a[52:55], v[36:39]
  ds_read_b64_tr_b16 v[142:143], v168 offset:16384
  s_waitcnt lgkmcnt(12)
  v_mfma_f32_16x16x32_bf16 v[40:43], v[156:159], a[48:51], v[40:43]
  ds_read_b64_tr_b16 v[144:145], v168 offset:160
  v_mfma_f32_16x16x32_bf16 v[44:47], v[156:159], a[52:55], v[44:47]
  ds_read_b64_tr_b16 v[146:147], v168 offset:1952
  s_waitcnt lgkmcnt(12)
  v_mfma_f32_16x16x32_bf16 v[48:51], v[160:163], a[48:51], v[48:51]
  ds_read_b64_tr_b16 v[148:149], v168 offset:14624
  v_mfma_f32_16x16x32_bf16 v[52:55], v[160:163], a[52:55], v[52:55]
  ds_read_b64_tr_b16 v[150:151], v168 offset:16416
  s_waitcnt lgkmcnt(12)
  v_mfma_f32_16x16x32_bf16 v[56:59], v[164:167], a[48:51], v[56:59]
  ds_read_b64_tr_b16 v[152:153], v168 offset:192
  v_mfma_f32_16x16x32_bf16 v[60:63], v[164:167], a[52:55], v[60:63]
  ds_read_b64_tr_b16 v[154:155], v168 offset:1984
  s_waitcnt lgkmcnt(12)
  v_mfma_f32_16x16x32_bf16 v[64:67], v[128:131], a[48:51], v[64:67]
  ds_read_b64_tr_b16 v[156:157], v168 offset:14656
  v_mfma_f32_16x16x32_bf16 v[68:71], v[128:131], a[52:55], v[68:71]
  ds_read_b64_tr_b16 v[158:159], v168 offset:16448
  s_waitcnt lgkmcnt(12)
  v_mfma_f32_16x16x32_bf16 v[72:75], v[132:135], a[48:51], v[72:75]
  ds_read_b64_tr_b16 v[160:161], v168 offset:7168
  v_mfma_f32_16x16x32_bf16 v[76:79], v[132:135], a[52:55], v[76:79]
  ds_read_b64_tr_b16 v[162:163], v168 offset:8960
  s_waitcnt lgkmcnt(12)
  v_mfma_f32_16x16x32_bf16 v[80:83], v[136:139], a[48:51], v[80:83]
  ds_read_b64_tr_b16 v[164:165], v168 offset:21632
  v_mfma_f32_16x16x32_bf16 v[84:87], v[136:139], a[52:55], v[84:87]
  ds_read_b64_tr_b16 v[166:167], v168 offset:23424
  buffer_load_dwordx4 a[28:31], v2, s[28:31], s67 offen offset:3072 sc1
  s_waitcnt lgkmcnt(12)
  v_mfma_f32_16x16x32_bf16 v[88:91], v[140:143], a[48:51], v[88:91]
  ds_read_b64_tr_b16 v[128:129], v168 offset:7200
  v_mfma_f32_16x16x32_bf16 v[92:95], v[140:143], a[52:55], v[92:95]
  ds_read_b64_tr_b16 v[130:131], v168 offset:8992
  s_waitcnt lgkmcnt(12)
  v_mfma_f32_16x16x32_bf16 v[96:99], v[144:147], a[48:51], v[96:99]
  ds_read_b64_tr_b16 v[132:133], v168 offset:21664
  v_mfma_f32_16x16x32_bf16 v[100:103], v[144:147], a[52:55], v[100:103]
  ds_read_b64_tr_b16 v[134:135], v168 offset:23456
  s_waitcnt lgkmcnt(12)
  v_mfma_f32_16x16x32_bf16 v[104:107], v[148:151], a[48:51], v[104:107]
  ds_read_b64_tr_b16 v[136:137], v168 offset:7232
  v_mfma_f32_16x16x32_bf16 v[108:111], v[148:151], a[52:55], v[108:111]
  ds_read_b64_tr_b16 v[138:139], v168 offset:9024
  s_waitcnt lgkmcnt(12)
  v_mfma_f32_16x16x32_bf16 v[112:115], v[152:155], a[48:51], v[112:115]
  ds_read_b64_tr_b16 v[140:141], v168 offset:21696
  v_mfma_f32_16x16x32_bf16 v[116:119], v[152:155], a[52:55], v[116:119]
  ds_read_b64_tr_b16 v[142:143], v168 offset:23488
  s_waitcnt lgkmcnt(12)
  v_mfma_f32_16x16x32_bf16 v[120:123], v[156:159], a[48:51], v[120:123]
  ds_read_b64_tr_b16 v[144:145], v168 offset:7264
  v_mfma_f32_16x16x32_bf16 v[124:127], v[156:159], a[52:55], v[124:127]
  ds_read_b64_tr_b16 v[146:147], v168 offset:9056
  s_waitcnt vmcnt(8)
  s_waitcnt lgkmcnt(12)
  v_mfma_f32_16x16x32_bf16 v[16:19], v[160:163], a[56:59], v[16:19]
  ds_read_b64_tr_b16 v[148:149], v168 offset:21728
  v_mfma_f32_16x16x32_bf16 v[20:23], v[160:163], a[60:63], v[20:23]
  ds_read_b64_tr_b16 v[150:151], v168 offset:23520
  s_waitcnt lgkmcnt(12)
  v_mfma_f32_16x16x32_bf16 v[24:27], v[164:167], a[56:59], v[24:27]
  ds_read_b64_tr_b16 v[152:153], v168 offset:7296
  v_mfma_f32_16x16x32_bf16 v[28:31], v[164:167], a[60:63], v[28:31]
  ds_read_b64_tr_b16 v[154:155], v168 offset:9088
  s_add_u32 s41, s41, 4096
  s_and_b32 s41, s41, 0x3fff
  s_add_u32 s66, s65, s41
  s_add_u32 s67, s66, 16384
  buffer_load_dwordx4 a[32:35], v2, s[28:31], s66 offen offset:0 sc1
  s_waitcnt lgkmcnt(12)
  v_mfma_f32_16x16x32_bf16 v[32:35], v[128:131], a[56:59], v[32:35]
  ds_read_b64_tr_b16 v[156:157], v168 offset:21760
  v_mfma_f32_16x16x32_bf16 v[36:39], v[128:131], a[60:63], v[36:39]
  ds_read_b64_tr_b16 v[158:159], v168 offset:23552
  s_waitcnt lgkmcnt(12)
  v_mfma_f32_16x16x32_bf16 v[40:43], v[132:135], a[56:59], v[40:43]
  ds_read_b64_tr_b16 v[160:161], v168 offset:7328
  v_mfma_f32_16x16x32_bf16 v[44:47], v[132:135], a[60:63], v[44:47]
  ds_read_b64_tr_b16 v[162:163], v168 offset:9120
  s_waitcnt lgkmcnt(12)
  v_mfma_f32_16x16x32_bf16 v[48:51], v[136:139], a[56:59], v[48:51]
  ds_read_b64_tr_b16 v[164:165], v168 offset:21792
  v_mfma_f32_16x16x32_bf16 v[52:55], v[136:139], a[60:63], v[52:55]
  ds_read_b64_tr_b16 v[166:167], v168 offset:23584
  s_waitcnt lgkmcnt(12)
  v_mfma_f32_16x16x32_bf16 v[56:59], v[140:143], a[56:59], v[56:59]
  ds_read_b64_tr_b16 v[128:129], v168 offset:7360
  v_mfma_f32_16x16x32_bf16 v[60:63], v[140:143], a[60:63], v[60:63]
  ds_read_b64_tr_b16 v[130:131], v168 offset:9152
  s_waitcnt lgkmcnt(12)
  v_mfma_f32_16x16x32_bf16 v[64:67], v[144:147], a[56:59], v[64:67]
  ds_read_b64_tr_b16 v[132:133], v168 offset:21824
  v_mfma_f32_16x16x32_bf16 v[68:71], v[144:147], a[60:63], v[68:71]
  ds_read_b64_tr_b16 v[134:135], v168 offset:23616
  s_barrier
  s_waitcnt lgkmcnt(12)
  v_mfma_f32_16x16x32_bf16 v[72:75], v[148:151], a[56:59], v[72:75]
  ds_read_b64_tr_b16 v[136:137], v168 offset:28800
  v_mfma_f32_16x16x32_bf16 v[76:79], v[148:151], a[60:63], v[76:79]
  ds_read_b64_tr_b16 v[138:139], v168 offset:30592
  s_waitcnt lgkmcnt(12)
  v_mfma_f32_16x16x32_bf16 v[80:83], v[152:155], a[56:59], v[80:83]
  ds_read_b64_tr_b16 v[140:141], v168 offset:43264
  v_mfma_f32_16x16x32_bf16 v[84:87], v[152:155], a[60:63], v[84:87]
  ds_read_b64_tr_b16 v[142:143], v168 offset:45056
  buffer_load_dwordx4 a[36:39], v2, s[28:31], s67 offen offset:0 sc1
  s_waitcnt lgkmcnt(12)
  v_mfma_f32_16x16x32_bf16 v[88:91], v[156:159], a[56:59], v[88:91]
  ds_read_b64_tr_b16 v[144:145], v168 offset:28832
  v_mfma_f32_16x16x32_bf16 v[92:95], v[156:159], a[60:63], v[92:95]
  ds_read_b64_tr_b16 v[146:147], v168 offset:30624
  s_waitcnt lgkmcnt(12)
  v_mfma_f32_16x16x32_bf16 v[96:99], v[160:163], a[56:59], v[96:99]
  ds_read_b64_tr_b16 v[148:149], v168 offset:43296
  v_mfma_f32_16x16x32_bf16 v[100:103], v[160:163], a[60:63], v[100:103]
  ds_read_b64_tr_b16 v[150:151], v168 offset:45088
  s_waitcnt lgkmcnt(12)
  v_mfma_f32_16x16x32_bf16 v[104:107], v[164:167], a[56:59], v[104:107]
  ds_read_b64_tr_b16 v[152:153], v168 offset:28864
  v_mfma_f32_16x16x32_bf16 v[108:111], v[164:167], a[60:63], v[108:111]
  ds_read_b64_tr_b16 v[154:155], v168 offset:30656
  s_waitcnt lgkmcnt(12)
  v_mfma_f32_16x16x32_bf16 v[112:115], v[128:131], a[56:59], v[112:115]
  ds_read_b64_tr_b16 v[156:157], v168 offset:43328
  v_mfma_f32_16x16x32_bf16 v[116:119], v[128:131], a[60:63], v[116:119]
  ds_read_b64_tr_b16 v[158:159], v168 offset:45120
  s_waitcnt lgkmcnt(12)
  v_mfma_f32_16x16x32_bf16 v[120:123], v[132:135], a[56:59], v[120:123]
  ds_read_b64_tr_b16 v[160:161], v168 offset:28896
  v_mfma_f32_16x16x32_bf16 v[124:127], v[132:135], a[60:63], v[124:127]
  ds_read_b64_tr_b16 v[162:163], v168 offset:30688
  s_waitcnt vmcnt(8)
  s_waitcnt lgkmcnt(12)
  v_mfma_f32_16x16x32_bf16 v[16:19], v[136:139], a[0:3], v[16:19]
  ds_read_b64_tr_b16 v[164:165], v168 offset:43360
  v_mfma_f32_16x16x32_bf16 v[20:23], v[136:139], a[4:7], v[20:23]
  ds_read_b64_tr_b16 v[166:167], v168 offset:45152
  s_waitcnt lgkmcnt(12)
  v_mfma_f32_16x16x32_bf16 v[24:27], v[140:143], a[0:3], v[24:27]
  ds_read_b64_tr_b16 v[128:129], v168 offset:28928
  v_mfma_f32_16x16x32_bf16 v[28:31], v[140:143], a[4:7], v[28:31]
  ds_read_b64_tr_b16 v[130:131], v168 offset:30720
  buffer_load_dwordx4 a[40:43], v2, s[28:31], s66 offen offset:1024 sc1
  s_waitcnt lgkmcnt(12)
  v_mfma_f32_16x16x32_bf16 v[32:35], v[144:147], a[0:3], v[32:35]
  ds_read_b64_tr_b16 v[132:133], v168 offset:43392
  v_mfma_f32_16x16x32_bf16 v[36:39], v[144:147], a[4:7], v[36:39]
  ds_read_b64_tr_b16 v[134:135], v168 offset:45184
  s_waitcnt lgkmcnt(12)
  v_mfma_f32_16x16x32_bf16 v[40:43], v[148:151], a[0:3], v[40:43]
  ds_read_b64_tr_b16 v[136:137], v168 offset:28960
  v_mfma_f32_16x16x32_bf16 v[44:47], v[148:151], a[4:7], v[44:47]
  ds_read_b64_tr_b16 v[138:139], v168 offset:30752
  s_waitcnt lgkmcnt(12)
  v_mfma_f32_16x16x32_bf16 v[48:51], v[152:155], a[0:3], v[48:51]
  ds_read_b64_tr_b16 v[140:141], v168 offset:43424
  v_mfma_f32_16x16x32_bf16 v[52:55], v[152:155], a[4:7], v[52:55]
  ds_read_b64_tr_b16 v[142:143], v168 offset:45216
  s_waitcnt lgkmcnt(12)
  v_mfma_f32_16x16x32_bf16 v[56:59], v[156:159], a[0:3], v[56:59]
  ds_read_b64_tr_b16 v[144:145], v168 offset:28992
  v_mfma_f32_16x16x32_bf16 v[60:63], v[156:159], a[4:7], v[60:63]
  ds_read_b64_tr_b16 v[146:147], v168 offset:30784
  s_waitcnt lgkmcnt(12)
  v_mfma_f32_16x16x32_bf16 v[64:67], v[160:163], a[0:3], v[64:67]
  ds_read_b64_tr_b16 v[148:149], v168 offset:43456
  v_mfma_f32_16x16x32_bf16 v[68:71], v[160:163], a[4:7], v[68:71]
  ds_read_b64_tr_b16 v[150:151], v168 offset:45248
  s_waitcnt lgkmcnt(12)
  v_mfma_f32_16x16x32_bf16 v[72:75], v[164:167], a[0:3], v[72:75]
  ds_read_b64_tr_b16 v[152:153], v168 offset:35968
  v_mfma_f32_16x16x32_bf16 v[76:79], v[164:167], a[4:7], v[76:79]
  ds_read_b64_tr_b16 v[154:155], v168 offset:37760
  s_waitcnt lgkmcnt(12)
  v_mfma_f32_16x16x32_bf16 v[80:83], v[128:131], a[0:3], v[80:83]
  ds_read_b64_tr_b16 v[156:157], v168 offset:50432
  v_mfma_f32_16x16x32_bf16 v[84:87], v[128:131], a[4:7], v[84:87]
  ds_read_b64_tr_b16 v[158:159], v168 offset:52224
  buffer_load_dwordx4 a[44:47], v2, s[28:31], s67 offen offset:1024 sc1
  s_waitcnt lgkmcnt(12)
  v_mfma_f32_16x16x32_bf16 v[88:91], v[132:135], a[0:3], v[88:91]
  ds_read_b64_tr_b16 v[160:161], v168 offset:36000
  v_mfma_f32_16x16x32_bf16 v[92:95], v[132:135], a[4:7], v[92:95]
  ds_read_b64_tr_b16 v[162:163], v168 offset:37792
  s_waitcnt lgkmcnt(12)
  v_mfma_f32_16x16x32_bf16 v[96:99], v[136:139], a[0:3], v[96:99]
  ds_read_b64_tr_b16 v[164:165], v168 offset:50464
  v_mfma_f32_16x16x32_bf16 v[100:103], v[136:139], a[4:7], v[100:103]
  ds_read_b64_tr_b16 v[166:167], v168 offset:52256
  s_waitcnt lgkmcnt(12)
  v_mfma_f32_16x16x32_bf16 v[104:107], v[140:143], a[0:3], v[104:107]
  ds_read_b64_tr_b16 v[128:129], v168 offset:36032
  v_mfma_f32_16x16x32_bf16 v[108:111], v[140:143], a[4:7], v[108:111]
  ds_read_b64_tr_b16 v[130:131], v168 offset:37824
  s_waitcnt lgkmcnt(12)
  v_mfma_f32_16x16x32_bf16 v[112:115], v[144:147], a[0:3], v[112:115]
  ds_read_b64_tr_b16 v[132:133], v168 offset:50496
  v_mfma_f32_16x16x32_bf16 v[116:119], v[144:147], a[4:7], v[116:119]
  ds_read_b64_tr_b16 v[134:135], v168 offset:52288
  s_waitcnt lgkmcnt(12)
  v_mfma_f32_16x16x32_bf16 v[120:123], v[148:151], a[0:3], v[120:123]
  ds_read_b64_tr_b16 v[136:137], v168 offset:36064
  v_mfma_f32_16x16x32_bf16 v[124:127], v[148:151], a[4:7], v[124:127]
  ds_read_b64_tr_b16 v[138:139], v168 offset:37856
  s_waitcnt vmcnt(8)
  s_waitcnt lgkmcnt(12)
  v_mfma_f32_16x16x32_bf16 v[16:19], v[152:155], a[8:11], v[16:19]
  ds_read_b64_tr_b16 v[140:141], v168 offset:50528
  v_mfma_f32_16x16x32_bf16 v[20:23], v[152:155], a[12:15], v[20:23]
  ds_read_b64_tr_b16 v[142:143], v168 offset:52320
  s_waitcnt lgkmcnt(12)
  v_mfma_f32_16x16x32_bf16 v[24:27], v[156:159], a[8:11], v[24:27]
  ds_read_b64_tr_b16 v[144:145], v168 offset:36096
  v_mfma_f32_16x16x32_bf16 v[28:31], v[156:159], a[12:15], v[28:31]
  ds_read_b64_tr_b16 v[146:147], v168 offset:37888
  buffer_load_dwordx4 a[48:51], v2, s[28:31], s66 offen offset:2048 sc1
  s_waitcnt lgkmcnt(12)
  v_mfma_f32_16x16x32_bf16 v[32:35], v[160:163], a[8:11], v[32:35]
  ds_read_b64_tr_b16 v[148:149], v168 offset:50560
  v_mfma_f32_16x16x32_bf16 v[36:39], v[160:163], a[12:15], v[36:39]
  ds_read_b64_tr_b16 v[150:151], v168 offset:52352
  s_waitcnt lgkmcnt(12)
  v_mfma_f32_16x16x32_bf16 v[40:43], v[164:167], a[8:11], v[40:43]
  ds_read_b64_tr_b16 v[152:153], v168 offset:36128
  v_mfma_f32_16x16x32_bf16 v[44:47], v[164:167], a[12:15], v[44:47]
  ds_read_b64_tr_b16 v[154:155], v168 offset:37920
  s_waitcnt lgkmcnt(12)
  v_mfma_f32_16x16x32_bf16 v[48:51], v[128:131], a[8:11], v[48:51]
  ds_read_b64_tr_b16 v[156:157], v168 offset:50592
  v_mfma_f32_16x16x32_bf16 v[52:55], v[128:131], a[12:15], v[52:55]
  ds_read_b64_tr_b16 v[158:159], v168 offset:52384
  s_waitcnt lgkmcnt(12)
  v_mfma_f32_16x16x32_bf16 v[56:59], v[132:135], a[8:11], v[56:59]
  ds_read_b64_tr_b16 v[160:161], v168 offset:36160
  v_mfma_f32_16x16x32_bf16 v[60:63], v[132:135], a[12:15], v[60:63]
  ds_read_b64_tr_b16 v[162:163], v168 offset:37952
  s_waitcnt lgkmcnt(12)
  v_mfma_f32_16x16x32_bf16 v[64:67], v[136:139], a[8:11], v[64:67]
  ds_read_b64_tr_b16 v[164:165], v168 offset:50624
  v_mfma_f32_16x16x32_bf16 v[68:71], v[136:139], a[12:15], v[68:71]
  ds_read_b64_tr_b16 v[166:167], v168 offset:52416
  s_barrier
  s_waitcnt lgkmcnt(12)
  v_mfma_f32_16x16x32_bf16 v[72:75], v[140:143], a[8:11], v[72:75]
  ds_read_b64_tr_b16 v[128:129], v169 offset:0
  v_mfma_f32_16x16x32_bf16 v[76:79], v[140:143], a[12:15], v[76:79]
  ds_read_b64_tr_b16 v[130:131], v169 offset:1792
  s_waitcnt lgkmcnt(12)
  v_mfma_f32_16x16x32_bf16 v[80:83], v[144:147], a[8:11], v[80:83]
  ds_read_b64_tr_b16 v[132:133], v169 offset:14464
  v_mfma_f32_16x16x32_bf16 v[84:87], v[144:147], a[12:15], v[84:87]
  ds_read_b64_tr_b16 v[134:135], v169 offset:16256
  buffer_load_dwordx4 a[52:55], v2, s[28:31], s67 offen offset:2048 sc1
  s_waitcnt lgkmcnt(12)
  v_mfma_f32_16x16x32_bf16 v[88:91], v[148:151], a[8:11], v[88:91]
  ds_read_b64_tr_b16 v[136:137], v169 offset:32
  v_mfma_f32_16x16x32_bf16 v[92:95], v[148:151], a[12:15], v[92:95]
  ds_read_b64_tr_b16 v[138:139], v169 offset:1824
  s_waitcnt lgkmcnt(12)
  v_mfma_f32_16x16x32_bf16 v[96:99], v[152:155], a[8:11], v[96:99]
  ds_read_b64_tr_b16 v[140:141], v169 offset:14496
  v_mfma_f32_16x16x32_bf16 v[100:103], v[152:155], a[12:15], v[100:103]
  ds_read_b64_tr_b16 v[142:143], v169 offset:16288
  s_waitcnt lgkmcnt(12)
  v_mfma_f32_16x16x32_bf16 v[104:107], v[156:159], a[8:11], v[104:107]
  ds_read_b64_tr_b16 v[144:145], v169 offset:64
  v_mfma_f32_16x16x32_bf16 v[108:111], v[156:159], a[12:15], v[108:111]
  ds_read_b64_tr_b16 v[146:147], v169 offset:1856
  s_waitcnt lgkmcnt(12)
  v_mfma_f32_16x16x32_bf16 v[112:115], v[160:163], a[8:11], v[112:115]
  ds_read_b64_tr_b16 v[148:149], v169 offset:14528
  v_mfma_f32_16x16x32_bf16 v[116:119], v[160:163], a[12:15], v[116:119]
  ds_read_b64_tr_b16 v[150:151], v169 offset:16320
  s_waitcnt lgkmcnt(12)
  v_mfma_f32_16x16x32_bf16 v[120:123], v[164:167], a[8:11], v[120:123]
  ds_read_b64_tr_b16 v[152:153], v169 offset:96
  v_mfma_f32_16x16x32_bf16 v[124:127], v[164:167], a[12:15], v[124:127]
  ds_read_b64_tr_b16 v[154:155], v169 offset:1888
  s_waitcnt vmcnt(8)
  s_waitcnt lgkmcnt(12)
  v_mfma_f32_16x16x32_bf16 v[16:19], v[128:131], a[16:19], v[16:19]
  ds_read_b64_tr_b16 v[156:157], v169 offset:14560
  v_mfma_f32_16x16x32_bf16 v[20:23], v[128:131], a[20:23], v[20:23]
  ds_read_b64_tr_b16 v[158:159], v169 offset:16352
  s_waitcnt lgkmcnt(12)
  v_mfma_f32_16x16x32_bf16 v[24:27], v[132:135], a[16:19], v[24:27]
  ds_read_b64_tr_b16 v[160:161], v169 offset:128
  v_mfma_f32_16x16x32_bf16 v[28:31], v[132:135], a[20:23], v[28:31]
  ds_read_b64_tr_b16 v[162:163], v169 offset:1920
  buffer_load_dwordx4 a[56:59], v2, s[28:31], s66 offen offset:3072 sc1
  s_waitcnt lgkmcnt(12)
  v_mfma_f32_16x16x32_bf16 v[32:35], v[136:139], a[16:19], v[32:35]
  ds_read_b64_tr_b16 v[164:165], v169 offset:14592
  v_mfma_f32_16x16x32_bf16 v[36:39], v[136:139], a[20:23], v[36:39]
  ds_read_b64_tr_b16 v[166:167], v169 offset:16384
  s_waitcnt lgkmcnt(12)
  v_mfma_f32_16x16x32_bf16 v[40:43], v[140:143], a[16:19], v[40:43]
  ds_read_b64_tr_b16 v[128:129], v169 offset:160
  v_mfma_f32_16x16x32_bf16 v[44:47], v[140:143], a[20:23], v[44:47]
  ds_read_b64_tr_b16 v[130:131], v169 offset:1952
  s_waitcnt lgkmcnt(12)
  v_mfma_f32_16x16x32_bf16 v[48:51], v[144:147], a[16:19], v[48:51]
  ds_read_b64_tr_b16 v[132:133], v169 offset:14624
  v_mfma_f32_16x16x32_bf16 v[52:55], v[144:147], a[20:23], v[52:55]
  ds_read_b64_tr_b16 v[134:135], v169 offset:16416
  s_waitcnt lgkmcnt(12)
  v_mfma_f32_16x16x32_bf16 v[56:59], v[148:151], a[16:19], v[56:59]
  ds_read_b64_tr_b16 v[136:137], v169 offset:192
  v_mfma_f32_16x16x32_bf16 v[60:63], v[148:151], a[20:23], v[60:63]
  ds_read_b64_tr_b16 v[138:139], v169 offset:1984
  s_waitcnt lgkmcnt(12)
  v_mfma_f32_16x16x32_bf16 v[64:67], v[152:155], a[16:19], v[64:67]
  ds_read_b64_tr_b16 v[140:141], v169 offset:14656
  v_mfma_f32_16x16x32_bf16 v[68:71], v[152:155], a[20:23], v[68:71]
  ds_read_b64_tr_b16 v[142:143], v169 offset:16448
  s_waitcnt lgkmcnt(12)
  v_mfma_f32_16x16x32_bf16 v[72:75], v[156:159], a[16:19], v[72:75]
  ds_read_b64_tr_b16 v[144:145], v169 offset:7168
  v_mfma_f32_16x16x32_bf16 v[76:79], v[156:159], a[20:23], v[76:79]
  ds_read_b64_tr_b16 v[146:147], v169 offset:8960
  s_waitcnt lgkmcnt(12)
  v_mfma_f32_16x16x32_bf16 v[80:83], v[160:163], a[16:19], v[80:83]
  ds_read_b64_tr_b16 v[148:149], v169 offset:21632
  v_mfma_f32_16x16x32_bf16 v[84:87], v[160:163], a[20:23], v[84:87]
  ds_read_b64_tr_b16 v[150:151], v169 offset:23424
  buffer_load_dwordx4 a[60:63], v2, s[28:31], s67 offen offset:3072 sc1
  s_waitcnt lgkmcnt(12)
  v_mfma_f32_16x16x32_bf16 v[88:91], v[164:167], a[16:19], v[88:91]
  ds_read_b64_tr_b16 v[152:153], v169 offset:7200
  v_mfma_f32_16x16x32_bf16 v[92:95], v[164:167], a[20:23], v[92:95]
  ds_read_b64_tr_b16 v[154:155], v169 offset:8992
  s_waitcnt lgkmcnt(12)
  v_mfma_f32_16x16x32_bf16 v[96:99], v[128:131], a[16:19], v[96:99]
  ds_read_b64_tr_b16 v[156:157], v169 offset:21664
  v_mfma_f32_16x16x32_bf16 v[100:103], v[128:131], a[20:23], v[100:103]
  ds_read_b64_tr_b16 v[158:159], v169 offset:23456
  s_waitcnt lgkmcnt(12)
  v_mfma_f32_16x16x32_bf16 v[104:107], v[132:135], a[16:19], v[104:107]
  ds_read_b64_tr_b16 v[160:161], v169 offset:7232
  v_mfma_f32_16x16x32_bf16 v[108:111], v[132:135], a[20:23], v[108:111]
  ds_read_b64_tr_b16 v[162:163], v169 offset:9024
  s_waitcnt lgkmcnt(12)
  v_mfma_f32_16x16x32_bf16 v[112:115], v[136:139], a[16:19], v[112:115]
  ds_read_b64_tr_b16 v[164:165], v169 offset:21696
  v_mfma_f32_16x16x32_bf16 v[116:119], v[136:139], a[20:23], v[116:119]
  ds_read_b64_tr_b16 v[166:167], v169 offset:23488
  s_waitcnt lgkmcnt(12)
  v_mfma_f32_16x16x32_bf16 v[120:123], v[140:143], a[16:19], v[120:123]
  ds_read_b64_tr_b16 v[128:129], v169 offset:7264
  v_mfma_f32_16x16x32_bf16 v[124:127], v[140:143], a[20:23], v[124:127]
  ds_read_b64_tr_b16 v[130:131], v169 offset:9056
  s_waitcnt vmcnt(8)
  s_waitcnt lgkmcnt(12)
  v_mfma_f32_16x16x32_bf16 v[16:19], v[144:147], a[24:27], v[16:19]
  ds_read_b64_tr_b16 v[132:133], v169 offset:21728
  v_mfma_f32_16x16x32_bf16 v[20:23], v[144:147], a[28:31], v[20:23]
  ds_read_b64_tr_b16 v[134:135], v169 offset:23520
  s_waitcnt lgkmcnt(12)
  v_mfma_f32_16x16x32_bf16 v[24:27], v[148:151], a[24:27], v[24:27]
  ds_read_b64_tr_b16 v[136:137], v169 offset:7296
  v_mfma_f32_16x16x32_bf16 v[28:31], v[148:151], a[28:31], v[28:31]
  ds_read_b64_tr_b16 v[138:139], v169 offset:9088
  s_waitcnt lgkmcnt(12)
  v_mfma_f32_16x16x32_bf16 v[32:35], v[152:155], a[24:27], v[32:35]
  ds_read_b64_tr_b16 v[140:141], v169 offset:21760
  v_mfma_f32_16x16x32_bf16 v[36:39], v[152:155], a[28:31], v[36:39]
  ds_read_b64_tr_b16 v[142:143], v169 offset:23552
  s_waitcnt lgkmcnt(12)
  v_mfma_f32_16x16x32_bf16 v[40:43], v[156:159], a[24:27], v[40:43]
  ds_read_b64_tr_b16 v[144:145], v169 offset:7328
  v_mfma_f32_16x16x32_bf16 v[44:47], v[156:159], a[28:31], v[44:47]
  ds_read_b64_tr_b16 v[146:147], v169 offset:9120
  s_waitcnt lgkmcnt(12)
  v_mfma_f32_16x16x32_bf16 v[48:51], v[160:163], a[24:27], v[48:51]
  ds_read_b64_tr_b16 v[148:149], v169 offset:21792
  v_mfma_f32_16x16x32_bf16 v[52:55], v[160:163], a[28:31], v[52:55]
  ds_read_b64_tr_b16 v[150:151], v169 offset:23584
  s_waitcnt lgkmcnt(12)
  v_mfma_f32_16x16x32_bf16 v[56:59], v[164:167], a[24:27], v[56:59]
  ds_read_b64_tr_b16 v[152:153], v169 offset:7360
  v_mfma_f32_16x16x32_bf16 v[60:63], v[164:167], a[28:31], v[60:63]
  ds_read_b64_tr_b16 v[154:155], v169 offset:9152
  s_waitcnt lgkmcnt(12)
  v_mfma_f32_16x16x32_bf16 v[64:67], v[128:131], a[24:27], v[64:67]
  ds_read_b64_tr_b16 v[156:157], v169 offset:21824
  v_mfma_f32_16x16x32_bf16 v[68:71], v[128:131], a[28:31], v[68:71]
  ds_read_b64_tr_b16 v[158:159], v169 offset:23616
  s_barrier
  s_waitcnt lgkmcnt(12)
  v_mfma_f32_16x16x32_bf16 v[72:75], v[132:135], a[24:27], v[72:75]
  ds_read_b64_tr_b16 v[160:161], v169 offset:28800
  v_mfma_f32_16x16x32_bf16 v[76:79], v[132:135], a[28:31], v[76:79]
  ds_read_b64_tr_b16 v[162:163], v169 offset:30592
  s_waitcnt lgkmcnt(12)
  v_mfma_f32_16x16x32_bf16 v[80:83], v[136:139], a[24:27], v[80:83]
  ds_read_b64_tr_b16 v[164:165], v169 offset:43264
  v_mfma_f32_16x16x32_bf16 v[84:87], v[136:139], a[28:31], v[84:87]
  ds_read_b64_tr_b16 v[166:167], v169 offset:45056
  s_waitcnt lgkmcnt(12)
  v_mfma_f32_16x16x32_bf16 v[88:91], v[140:143], a[24:27], v[88:91]
  ds_read_b64_tr_b16 v[128:129], v169 offset:28832
  v_mfma_f32_16x16x32_bf16 v[92:95], v[140:143], a[28:31], v[92:95]
  ds_read_b64_tr_b16 v[130:131], v169 offset:30624
  s_waitcnt lgkmcnt(12)
  v_mfma_f32_16x16x32_bf16 v[96:99], v[144:147], a[24:27], v[96:99]
  ds_read_b64_tr_b16 v[132:133], v169 offset:43296
  v_mfma_f32_16x16x32_bf16 v[100:103], v[144:147], a[28:31], v[100:103]
  ds_read_b64_tr_b16 v[134:135], v169 offset:45088
  s_waitcnt lgkmcnt(12)
  v_mfma_f32_16x16x32_bf16 v[104:107], v[148:151], a[24:27], v[104:107]
  ds_read_b64_tr_b16 v[136:137], v169 offset:28864
  v_mfma_f32_16x16x32_bf16 v[108:111], v[148:151], a[28:31], v[108:111]
  ds_read_b64_tr_b16 v[138:139], v169 offset:30656
  s_waitcnt lgkmcnt(12)
  v_mfma_f32_16x16x32_bf16 v[112:115], v[152:155], a[24:27], v[112:115]
  ds_read_b64_tr_b16 v[140:141], v169 offset:43328
  v_mfma_f32_16x16x32_bf16 v[116:119], v[152:155], a[28:31], v[116:119]
  ds_read_b64_tr_b16 v[142:143], v169 offset:45120
  s_waitcnt lgkmcnt(12)
  v_mfma_f32_16x16x32_bf16 v[120:123], v[156:159], a[24:27], v[120:123]
  ds_read_b64_tr_b16 v[144:145], v169 offset:28896
  v_mfma_f32_16x16x32_bf16 v[124:127], v[156:159], a[28:31], v[124:127]
  ds_read_b64_tr_b16 v[146:147], v169 offset:30688
  s_waitcnt vmcnt(6)
  s_waitcnt lgkmcnt(12)
  v_mfma_f32_16x16x32_bf16 v[16:19], v[160:163], a[32:35], v[16:19]
  ds_read_b64_tr_b16 v[148:149], v169 offset:43360
  v_mfma_f32_16x16x32_bf16 v[20:23], v[160:163], a[36:39], v[20:23]
  ds_read_b64_tr_b16 v[150:151], v169 offset:45152
  s_waitcnt lgkmcnt(12)
  v_mfma_f32_16x16x32_bf16 v[24:27], v[164:167], a[32:35], v[24:27]
  ds_read_b64_tr_b16 v[152:153], v169 offset:28928
  v_mfma_f32_16x16x32_bf16 v[28:31], v[164:167], a[36:39], v[28:31]
  ds_read_b64_tr_b16 v[154:155], v169 offset:30720
  s_waitcnt lgkmcnt(12)
  v_mfma_f32_16x16x32_bf16 v[32:35], v[128:131], a[32:35], v[32:35]
  ds_read_b64_tr_b16 v[156:157], v169 offset:43392
  v_mfma_f32_16x16x32_bf16 v[36:39], v[128:131], a[36:39], v[36:39]
  ds_read_b64_tr_b16 v[158:159], v169 offset:45184
  s_waitcnt lgkmcnt(12)
  v_mfma_f32_16x16x32_bf16 v[40:43], v[132:135], a[32:35], v[40:43]
  ds_read_b64_tr_b16 v[160:161], v169 offset:28960
  v_mfma_f32_16x16x32_bf16 v[44:47], v[132:135], a[36:39], v[44:47]
  ds_read_b64_tr_b16 v[162:163], v169 offset:30752
  s_waitcnt lgkmcnt(12)
  v_mfma_f32_16x16x32_bf16 v[48:51], v[136:139], a[32:35], v[48:51]
  ds_read_b64_tr_b16 v[164:165], v169 offset:43424
  v_mfma_f32_16x16x32_bf16 v[52:55], v[136:139], a[36:39], v[52:55]
  ds_read_b64_tr_b16 v[166:167], v169 offset:45216
  s_waitcnt lgkmcnt(12)
  v_mfma_f32_16x16x32_bf16 v[56:59], v[140:143], a[32:35], v[56:59]
  ds_read_b64_tr_b16 v[128:129], v169 offset:28992
  v_mfma_f32_16x16x32_bf16 v[60:63], v[140:143], a[36:39], v[60:63]
  ds_read_b64_tr_b16 v[130:131], v169 offset:30784
  s_waitcnt lgkmcnt(12)
  v_mfma_f32_16x16x32_bf16 v[64:67], v[144:147], a[32:35], v[64:67]
  ds_read_b64_tr_b16 v[132:133], v169 offset:43456
  v_mfma_f32_16x16x32_bf16 v[68:71], v[144:147], a[36:39], v[68:71]
  ds_read_b64_tr_b16 v[134:135], v169 offset:45248
  s_waitcnt lgkmcnt(12)
  v_mfma_f32_16x16x32_bf16 v[72:75], v[148:151], a[32:35], v[72:75]
  ds_read_b64_tr_b16 v[136:137], v169 offset:35968
  v_mfma_f32_16x16x32_bf16 v[76:79], v[148:151], a[36:39], v[76:79]
  ds_read_b64_tr_b16 v[138:139], v169 offset:37760
  s_waitcnt lgkmcnt(12)
  v_mfma_f32_16x16x32_bf16 v[80:83], v[152:155], a[32:35], v[80:83]
  ds_read_b64_tr_b16 v[140:141], v169 offset:50432
  v_mfma_f32_16x16x32_bf16 v[84:87], v[152:155], a[36:39], v[84:87]
  ds_read_b64_tr_b16 v[142:143], v169 offset:52224
  s_waitcnt lgkmcnt(12)
  v_mfma_f32_16x16x32_bf16 v[88:91], v[156:159], a[32:35], v[88:91]
  ds_read_b64_tr_b16 v[144:145], v169 offset:36000
  v_mfma_f32_16x16x32_bf16 v[92:95], v[156:159], a[36:39], v[92:95]
  ds_read_b64_tr_b16 v[146:147], v169 offset:37792
  s_waitcnt lgkmcnt(12)
  v_mfma_f32_16x16x32_bf16 v[96:99], v[160:163], a[32:35], v[96:99]
  ds_read_b64_tr_b16 v[148:149], v169 offset:50464
  v_mfma_f32_16x16x32_bf16 v[100:103], v[160:163], a[36:39], v[100:103]
  ds_read_b64_tr_b16 v[150:151], v169 offset:52256
  s_waitcnt lgkmcnt(12)
  v_mfma_f32_16x16x32_bf16 v[104:107], v[164:167], a[32:35], v[104:107]
  ds_read_b64_tr_b16 v[152:153], v169 offset:36032
  v_mfma_f32_16x16x32_bf16 v[108:111], v[164:167], a[36:39], v[108:111]
  ds_read_b64_tr_b16 v[154:155], v169 offset:37824
  s_waitcnt lgkmcnt(12)
  v_mfma_f32_16x16x32_bf16 v[112:115], v[128:131], a[32:35], v[112:115]
  ds_read_b64_tr_b16 v[156:157], v169 offset:50496
  v_mfma_f32_16x16x32_bf16 v[116:119], v[128:131], a[36:39], v[116:119]
  ds_read_b64_tr_b16 v[158:159], v169 offset:52288
  s_waitcnt lgkmcnt(12)
  v_mfma_f32_16x16x32_bf16 v[120:123], v[132:135], a[32:35], v[120:123]
  ds_read_b64_tr_b16 v[160:161], v169 offset:36064
  v_mfma_f32_16x16x32_bf16 v[124:127], v[132:135], a[36:39], v[124:127]
  ds_read_b64_tr_b16 v[162:163], v169 offset:37856
  s_waitcnt vmcnt(4)
  s_waitcnt lgkmcnt(12)
  v_mfma_f32_16x16x32_bf16 v[16:19], v[136:139], a[40:43], v[16:19]
  ds_read_b64_tr_b16 v[164:165], v169 offset:50528
  v_mfma_f32_16x16x32_bf16 v[20:23], v[136:139], a[44:47], v[20:23]
  ds_read_b64_tr_b16 v[166:167], v169 offset:52320
  s_waitcnt lgkmcnt(12)
  v_mfma_f32_16x16x32_bf16 v[24:27], v[140:143], a[40:43], v[24:27]
  ds_read_b64_tr_b16 v[128:129], v169 offset:36096
  v_mfma_f32_16x16x32_bf16 v[28:31], v[140:143], a[44:47], v[28:31]
  ds_read_b64_tr_b16 v[130:131], v169 offset:37888
  s_waitcnt lgkmcnt(12)
  v_mfma_f32_16x16x32_bf16 v[32:35], v[144:147], a[40:43], v[32:35]
  ds_read_b64_tr_b16 v[132:133], v169 offset:50560
  v_mfma_f32_16x16x32_bf16 v[36:39], v[144:147], a[44:47], v[36:39]
  ds_read_b64_tr_b16 v[134:135], v169 offset:52352
  buffer_load_dwordx4 v[176:179], v171, s[28:31], s68 offen sc1
  buffer_load_dwordx4 v[180:183], v171, s[28:31], s68 offen offset:1024 sc1
  s_waitcnt lgkmcnt(12)
  v_mfma_f32_16x16x32_bf16 v[40:43], v[148:151], a[40:43], v[40:43]
  ds_read_b64_tr_b16 v[136:137], v169 offset:36128
  v_mfma_f32_16x16x32_bf16 v[44:47], v[148:151], a[44:47], v[44:47]
  ds_read_b64_tr_b16 v[138:139], v169 offset:37920
  s_waitcnt lgkmcnt(12)
  v_mfma_f32_16x16x32_bf16 v[48:51], v[152:155], a[40:43], v[48:51]
  ds_read_b64_tr_b16 v[140:141], v169 offset:50592
  v_mfma_f32_16x16x32_bf16 v[52:55], v[152:155], a[44:47], v[52:55]
  ds_read_b64_tr_b16 v[142:143], v169 offset:52384
  s_waitcnt lgkmcnt(12)
  v_mfma_f32_16x16x32_bf16 v[56:59], v[156:159], a[40:43], v[56:59]
  ds_read_b64_tr_b16 v[144:145], v169 offset:36160
  v_mfma_f32_16x16x32_bf16 v[60:63], v[156:159], a[44:47], v[60:63]
  ds_read_b64_tr_b16 v[146:147], v169 offset:37952
  s_waitcnt lgkmcnt(12)
  v_mfma_f32_16x16x32_bf16 v[64:67], v[160:163], a[40:43], v[64:67]
  ds_read_b64_tr_b16 v[148:149], v169 offset:50624
  v_mfma_f32_16x16x32_bf16 v[68:71], v[160:163], a[44:47], v[68:71]
  ds_read_b64_tr_b16 v[150:151], v169 offset:52416
  s_barrier
  s_waitcnt lgkmcnt(12)
  v_mfma_f32_16x16x32_bf16 v[72:75], v[164:167], a[40:43], v[72:75]
  ds_read_b64_tr_b16 v[152:153], v169 offset:57600
  v_mfma_f32_16x16x32_bf16 v[76:79], v[164:167], a[44:47], v[76:79]
  ds_read_b64_tr_b16 v[154:155], v169 offset:59392
  s_waitcnt lgkmcnt(12)
  v_mfma_f32_16x16x32_bf16 v[80:83], v[128:131], a[40:43], v[80:83]
  ds_read_b64_tr_b16 v[156:157], v170 offset:6528
  v_mfma_f32_16x16x32_bf16 v[84:87], v[128:131], a[44:47], v[84:87]
  ds_read_b64_tr_b16 v[158:159], v170 offset:8320
  s_waitcnt lgkmcnt(12)
  v_mfma_f32_16x16x32_bf16 v[88:91], v[132:135], a[40:43], v[88:91]
  ds_read_b64_tr_b16 v[160:161], v169 offset:57632
  v_mfma_f32_16x16x32_bf16 v[92:95], v[132:135], a[44:47], v[92:95]
  ds_read_b64_tr_b16 v[162:163], v169 offset:59424
  s_waitcnt lgkmcnt(12)
  v_mfma_f32_16x16x32_bf16 v[96:99], v[136:139], a[40:43], v[96:99]
  ds_read_b64_tr_b16 v[164:165], v170 offset:6560
  v_mfma_f32_16x16x32_bf16 v[100:103], v[136:139], a[44:47], v[100:103]
  ds_read_b64_tr_b16 v[166:167], v170 offset:8352
  s_waitcnt lgkmcnt(12)
  v_mfma_f32_16x16x32_bf16 v[104:107], v[140:143], a[40:43], v[104:107]
  ds_read_b64_tr_b16 v[128:129], v169 offset:57664
  v_mfma_f32_16x16x32_bf16 v[108:111], v[140:143], a[44:47], v[108:111]
  ds_read_b64_tr_b16 v[130:131], v169 offset:59456
  s_waitcnt lgkmcnt(12)
  v_mfma_f32_16x16x32_bf16 v[112:115], v[144:147], a[40:43], v[112:115]
  ds_read_b64_tr_b16 v[132:133], v170 offset:6592
  v_mfma_f32_16x16x32_bf16 v[116:119], v[144:147], a[44:47], v[116:119]
  ds_read_b64_tr_b16 v[134:135], v170 offset:8384
  s_waitcnt lgkmcnt(12)
  v_mfma_f32_16x16x32_bf16 v[120:123], v[148:151], a[40:43], v[120:123]
  ds_read_b64_tr_b16 v[136:137], v169 offset:57696
  v_mfma_f32_16x16x32_bf16 v[124:127], v[148:151], a[44:47], v[124:127]
  ds_read_b64_tr_b16 v[138:139], v169 offset:59488
  s_waitcnt vmcnt(4)
  s_waitcnt lgkmcnt(12)
  v_mfma_f32_16x16x32_bf16 v[16:19], v[152:155], a[48:51], v[16:19]
  ds_read_b64_tr_b16 v[140:141], v170 offset:6624
  v_mfma_f32_16x16x32_bf16 v[20:23], v[152:155], a[52:55], v[20:23]
  ds_read_b64_tr_b16 v[142:143], v170 offset:8416
  s_waitcnt lgkmcnt(12)
  v_mfma_f32_16x16x32_bf16 v[24:27], v[156:159], a[48:51], v[24:27]
  ds_read_b64_tr_b16 v[144:145], v169 offset:57728
  v_mfma_f32_16x16x32_bf16 v[28:31], v[156:159], a[52:55], v[28:31]
  ds_read_b64_tr_b16 v[146:147], v169 offset:59520
  s_waitcnt lgkmcnt(12)
  v_mfma_f32_16x16x32_bf16 v[32:35], v[160:163], a[48:51], v[32:35]
  ds_read_b64_tr_b16 v[148:149], v170 offset:6656
  v_mfma_f32_16x16x32_bf16 v[36:39], v[160:163], a[52:55], v[36:39]
  ds_read_b64_tr_b16 v[150:151], v170 offset:8448
  s_waitcnt lgkmcnt(12)
  v_mfma_f32_16x16x32_bf16 v[40:43], v[164:167], a[48:51], v[40:43]
  ds_read_b64_tr_b16 v[152:153], v169 offset:57760
  v_mfma_f32_16x16x32_bf16 v[44:47], v[164:167], a[52:55], v[44:47]
  ds_read_b64_tr_b16 v[154:155], v169 offset:59552
  s_waitcnt lgkmcnt(12)
  v_mfma_f32_16x16x32_bf16 v[48:51], v[128:131], a[48:51], v[48:51]
  ds_read_b64_tr_b16 v[156:157], v170 offset:6688
  v_mfma_f32_16x16x32_bf16 v[52:55], v[128:131], a[52:55], v[52:55]
  ds_read_b64_tr_b16 v[158:159], v170 offset:8480
  s_waitcnt lgkmcnt(12)
  v_mfma_f32_16x16x32_bf16 v[56:59], v[132:135], a[48:51], v[56:59]
  ds_read_b64_tr_b16 v[160:161], v169 offset:57792
  v_mfma_f32_16x16x32_bf16 v[60:63], v[132:135], a[52:55], v[60:63]
  ds_read_b64_tr_b16 v[162:163], v169 offset:59584
  s_waitcnt lgkmcnt(12)
  v_mfma_f32_16x16x32_bf16 v[64:67], v[136:139], a[48:51], v[64:67]
  ds_read_b64_tr_b16 v[164:165], v170 offset:6720
  v_mfma_f32_16x16x32_bf16 v[68:71], v[136:139], a[52:55], v[68:71]
  ds_read_b64_tr_b16 v[166:167], v170 offset:8512
  s_waitcnt lgkmcnt(12)
  v_mfma_f32_16x16x32_bf16 v[72:75], v[140:143], a[48:51], v[72:75]
  ds_read_b64_tr_b16 v[128:129], v169 offset:64768
  v_mfma_f32_16x16x32_bf16 v[76:79], v[140:143], a[52:55], v[76:79]
  ds_read_b64_tr_b16 v[130:131], v170 offset:1024
  s_waitcnt lgkmcnt(12)
  v_mfma_f32_16x16x32_bf16 v[80:83], v[144:147], a[48:51], v[80:83]
  ds_read_b64_tr_b16 v[132:133], v170 offset:13696
  v_mfma_f32_16x16x32_bf16 v[84:87], v[144:147], a[52:55], v[84:87]
  ds_read_b64_tr_b16 v[134:135], v170 offset:15488
  s_waitcnt lgkmcnt(12)
  v_mfma_f32_16x16x32_bf16 v[88:91], v[148:151], a[48:51], v[88:91]
  ds_read_b64_tr_b16 v[136:137], v169 offset:64800
  v_mfma_f32_16x16x32_bf16 v[92:95], v[148:151], a[52:55], v[92:95]
  ds_read_b64_tr_b16 v[138:139], v170 offset:1056
  s_waitcnt lgkmcnt(12)
  v_mfma_f32_16x16x32_bf16 v[96:99], v[152:155], a[48:51], v[96:99]
  ds_read_b64_tr_b16 v[140:141], v170 offset:13728
  v_mfma_f32_16x16x32_bf16 v[100:103], v[152:155], a[52:55], v[100:103]
  ds_read_b64_tr_b16 v[142:143], v170 offset:15520
  s_waitcnt lgkmcnt(12)
  v_mfma_f32_16x16x32_bf16 v[104:107], v[156:159], a[48:51], v[104:107]
  ds_read_b64_tr_b16 v[144:145], v169 offset:64832
  v_mfma_f32_16x16x32_bf16 v[108:111], v[156:159], a[52:55], v[108:111]
  ds_read_b64_tr_b16 v[146:147], v170 offset:1088
  s_waitcnt lgkmcnt(12)
  v_mfma_f32_16x16x32_bf16 v[112:115], v[160:163], a[48:51], v[112:115]
  ds_read_b64_tr_b16 v[148:149], v170 offset:13760
  v_mfma_f32_16x16x32_bf16 v[116:119], v[160:163], a[52:55], v[116:119]
  ds_read_b64_tr_b16 v[150:151], v170 offset:15552
  s_waitcnt lgkmcnt(12)
  v_mfma_f32_16x16x32_bf16 v[120:123], v[164:167], a[48:51], v[120:123]
  ds_read_b64_tr_b16 v[152:153], v169 offset:64864
  v_mfma_f32_16x16x32_bf16 v[124:127], v[164:167], a[52:55], v[124:127]
  ds_read_b64_tr_b16 v[154:155], v170 offset:1120
  s_waitcnt vmcnt(2)
  s_waitcnt lgkmcnt(12)
  v_mfma_f32_16x16x32_bf16 v[16:19], v[128:131], a[56:59], v[16:19]
  ds_read_b64_tr_b16 v[156:157], v170 offset:13792
  v_mfma_f32_16x16x32_bf16 v[20:23], v[128:131], a[60:63], v[20:23]
  ds_read_b64_tr_b16 v[158:159], v170 offset:15584
  s_waitcnt lgkmcnt(12)
  v_mfma_f32_16x16x32_bf16 v[24:27], v[132:135], a[56:59], v[24:27]
  ds_read_b64_tr_b16 v[160:161], v169 offset:64896
  v_mfma_f32_16x16x32_bf16 v[28:31], v[132:135], a[60:63], v[28:31]
  ds_read_b64_tr_b16 v[162:163], v170 offset:1152
  s_waitcnt lgkmcnt(12)
  v_mfma_f32_16x16x32_bf16 v[32:35], v[136:139], a[56:59], v[32:35]
  ds_read_b64_tr_b16 v[164:165], v170 offset:13824
  v_mfma_f32_16x16x32_bf16 v[36:39], v[136:139], a[60:63], v[36:39]
  ds_read_b64_tr_b16 v[166:167], v170 offset:15616
  s_waitcnt lgkmcnt(12)
  v_mfma_f32_16x16x32_bf16 v[40:43], v[140:143], a[56:59], v[40:43]
  ds_read_b64_tr_b16 v[128:129], v169 offset:64928
  v_mfma_f32_16x16x32_bf16 v[44:47], v[140:143], a[60:63], v[44:47]
  ds_read_b64_tr_b16 v[130:131], v170 offset:1184
  s_waitcnt lgkmcnt(12)
  v_mfma_f32_16x16x32_bf16 v[48:51], v[144:147], a[56:59], v[48:51]
  ds_read_b64_tr_b16 v[132:133], v170 offset:13856
  v_mfma_f32_16x16x32_bf16 v[52:55], v[144:147], a[60:63], v[52:55]
  ds_read_b64_tr_b16 v[134:135], v170 offset:15648
  s_waitcnt lgkmcnt(12)
  v_mfma_f32_16x16x32_bf16 v[56:59], v[148:151], a[56:59], v[56:59]
  ds_read_b64_tr_b16 v[136:137], v169 offset:64960
  v_mfma_f32_16x16x32_bf16 v[60:63], v[148:151], a[60:63], v[60:63]
  ds_read_b64_tr_b16 v[138:139], v170 offset:1216
  s_waitcnt lgkmcnt(12)
  v_mfma_f32_16x16x32_bf16 v[64:67], v[152:155], a[56:59], v[64:67]
  ds_read_b64_tr_b16 v[140:141], v170 offset:13888
  v_mfma_f32_16x16x32_bf16 v[68:71], v[152:155], a[60:63], v[68:71]
  ds_read_b64_tr_b16 v[142:143], v170 offset:15680
  s_barrier
  s_waitcnt lgkmcnt(12)
  v_mfma_f32_16x16x32_bf16 v[72:75], v[156:159], a[56:59], v[72:75]
  v_mfma_f32_16x16x32_bf16 v[76:79], v[156:159], a[60:63], v[76:79]
  s_waitcnt lgkmcnt(10)
  v_mfma_f32_16x16x32_bf16 v[80:83], v[160:163], a[56:59], v[80:83]
  v_mfma_f32_16x16x32_bf16 v[84:87], v[160:163], a[60:63], v[84:87]
  s_waitcnt lgkmcnt(8)
  v_mfma_f32_16x16x32_bf16 v[88:91], v[164:167], a[56:59], v[88:91]
  v_mfma_f32_16x16x32_bf16 v[92:95], v[164:167], a[60:63], v[92:95]
  s_waitcnt lgkmcnt(6)
  v_mfma_f32_16x16x32_bf16 v[96:99], v[128:131], a[56:59], v[96:99]
  v_mfma_f32_16x16x32_bf16 v[100:103], v[128:131], a[60:63], v[100:103]
  s_waitcnt lgkmcnt(4)
  v_mfma_f32_16x16x32_bf16 v[104:107], v[132:135], a[56:59], v[104:107]
  v_mfma_f32_16x16x32_bf16 v[108:111], v[132:135], a[60:63], v[108:111]
  s_waitcnt lgkmcnt(2)
  v_mfma_f32_16x16x32_bf16 v[112:115], v[136:139], a[56:59], v[112:115]
  v_mfma_f32_16x16x32_bf16 v[116:119], v[136:139], a[60:63], v[116:119]
  s_waitcnt lgkmcnt(0)
  v_mfma_f32_16x16x32_bf16 v[120:123], v[140:143], a[56:59], v[120:123]
  v_mfma_f32_16x16x32_bf16 v[124:127], v[140:143], a[60:63], v[124:127]
  s_barrier
  s_waitcnt vmcnt(0)
  v_pk_add_f32 v[176:177], v[176:177], v[178:179]
  v_pk_add_f32 v[180:181], v[180:181], v[182:183]
  v_add_f32 v176, v176, v177
  v_add_f32 v180, v180, v181
  s_nop 1
  v_permlane32_swap_b32 v176, v180
  v_add_f32 v176, v176, v180
  v_mov_b32 v177, v176
  s_nop 1
  v_permlane16_swap_b32 v176, v177
  v_add_f32 v176, v176, v177
  v_mul_f32 v176, 0x3b000000, v176
  v_add_f32 v176, 0x3727c5ac, v176
  v_rsq_f32 v178, v176
  s_nop 0
  v_mov_b32 v180, v178
  s_nop 1
  v_permlane32_swap_b32 v178, v180
  v_mul_f32 v182, 0xbfb8aa3b, v178
  v_mul_f32 v184, 0xbfb8aa3b, v180
  v_mov_b32 v186, 1.0
  s_lshr_b32 s47, s51, 5
  s_add_u32 s47, s47, s38
  s_mul_i32 s47, s47, 112
  s_mul_i32 s48, s64, 7
  s_add_u32 s47, s47, s48
  s_lshl_b32 s47, s47, 10
  s_add_u32 s66, s47, 4194304
  s_add_u32 s68, s66, 4096
  v_pk_mul_f32 v[16:17], v[16:17], v[182:183] op_sel_hi:[1,0]
  v_pk_mul_f32 v[18:19], v[18:19], v[182:183] op_sel_hi:[1,0]
  v_pk_mul_f32 v[20:21], v[20:21], v[184:185] op_sel_hi:[1,0]
  v_pk_mul_f32 v[22:23], v[22:23], v[184:185] op_sel_hi:[1,0]
  v_exp_f32 v16, v16
  v_exp_f32 v17, v17
  v_exp_f32 v18, v18
  v_exp_f32 v19, v19
  v_exp_f32 v20, v20
  v_exp_f32 v21, v21
  v_exp_f32 v22, v22
  v_exp_f32 v23, v23
  v_pk_mul_f32 v[24:25], v[24:25], v[178:179] op_sel_hi:[1,0]
  v_pk_mul_f32 v[26:27], v[26:27], v[178:179] op_sel_hi:[1,0]
  v_pk_mul_f32 v[28:29], v[28:29], v[180:181] op_sel_hi:[1,0]
  v_pk_mul_f32 v[30:31], v[30:31], v[180:181] op_sel_hi:[1,0]
  v_pk_add_f32 v[16:17], v[16:17], v[186:187] op_sel_hi:[1,0]
  v_pk_add_f32 v[18:19], v[18:19], v[186:187] op_sel_hi:[1,0]
  v_pk_add_f32 v[20:21], v[20:21], v[186:187] op_sel_hi:[1,0]
  v_pk_add_f32 v[22:23], v[22:23], v[186:187] op_sel_hi:[1,0]
  v_rcp_f32 v16, v16
  v_rcp_f32 v17, v17
  v_rcp_f32 v18, v18
  v_rcp_f32 v19, v19
  v_rcp_f32 v20, v20
  v_rcp_f32 v21, v21
  v_rcp_f32 v22, v22
  v_rcp_f32 v23, v23
  v_pk_mul_f32 v[24:25], v[24:25], v[16:17]
  v_pk_mul_f32 v[26:27], v[26:27], v[18:19]
  v_pk_mul_f32 v[28:29], v[28:29], v[20:21]
  v_pk_mul_f32 v[30:31], v[30:31], v[22:23]
  v_cvt_pk_bf16_f32 v128, v24, v25
  v_cvt_pk_bf16_f32 v129, v26, v27
  v_cvt_pk_bf16_f32 v130, v28, v29
  v_cvt_pk_bf16_f32 v131, v30, v31
  s_nop 0
  v_permlane32_swap_b32 v128, v130
  v_permlane32_swap_b32 v129, v131
  buffer_store_dwordx4 v[128:131], v172, s[28:31], s66 offen offset:0 sc1
  v_pk_mul_f32 v[32:33], v[32:33], v[182:183] op_sel_hi:[1,0]
  v_pk_mul_f32 v[34:35], v[34:35], v[182:183] op_sel_hi:[1,0]
  v_pk_mul_f32 v[36:37], v[36:37], v[184:185] op_sel_hi:[1,0]
  v_pk_mul_f32 v[38:39], v[38:39], v[184:185] op_sel_hi:[1,0]
  v_exp_f32 v32, v32
  v_exp_f32 v33, v33
  v_exp_f32 v34, v34
  v_exp_f32 v35, v35
  v_exp_f32 v36, v36
  v_exp_f32 v37, v37
  v_exp_f32 v38, v38
  v_exp_f32 v39, v39
  v_pk_mul_f32 v[40:41], v[40:41], v[178:179] op_sel_hi:[1,0]
  v_pk_mul_f32 v[42:43], v[42:43], v[178:179] op_sel_hi:[1,0]
  v_pk_mul_f32 v[44:45], v[44:45], v[180:181] op_sel_hi:[1,0]
  v_pk_mul_f32 v[46:47], v[46:47], v[180:181] op_sel_hi:[1,0]
  v_pk_add_f32 v[32:33], v[32:33], v[186:187] op_sel_hi:[1,0]
  v_pk_add_f32 v[34:35], v[34:35], v[186:187] op_sel_hi:[1,0]
  v_pk_add_f32 v[36:37], v[36:37], v[186:187] op_sel_hi:[1,0]
  v_pk_add_f32 v[38:39], v[38:39], v[186:187] op_sel_hi:[1,0]
  v_rcp_f32 v32, v32
  v_rcp_f32 v33, v33
  v_rcp_f32 v34, v34
  v_rcp_f32 v35, v35
  v_rcp_f32 v36, v36
  v_rcp_f32 v37, v37
  v_rcp_f32 v38, v38
  v_rcp_f32 v39, v39
  v_pk_mul_f32 v[40:41], v[40:41], v[32:33]
  v_pk_mul_f32 v[42:43], v[42:43], v[34:35]
  v_pk_mul_f32 v[44:45], v[44:45], v[36:37]
  v_pk_mul_f32 v[46:47], v[46:47], v[38:39]
  v_cvt_pk_bf16_f32 v132, v40, v41
  v_cvt_pk_bf16_f32 v133, v42, v43
  v_cvt_pk_bf16_f32 v134, v44, v45
  v_cvt_pk_bf16_f32 v135, v46, v47
  s_nop 0
  v_permlane32_swap_b32 v132, v134
  v_permlane32_swap_b32 v133, v135
  buffer_store_dwordx4 v[132:135], v172, s[28:31], s66 offen offset:1024 sc1
  v_pk_mul_f32 v[48:49], v[48:49], v[182:183] op_sel_hi:[1,0]
  v_pk_mul_f32 v[50:51], v[50:51], v[182:183] op_sel_hi:[1,0]
  v_pk_mul_f32 v[52:53], v[52:53], v[184:185] op_sel_hi:[1,0]
  v_pk_mul_f32 v[54:55], v[54:55], v[184:185] op_sel_hi:[1,0]
  v_exp_f32 v48, v48
  v_exp_f32 v49, v49
  v_exp_f32 v50, v50
  v_exp_f32 v51, v51
  v_exp_f32 v52, v52
  v_exp_f32 v53, v53
  v_exp_f32 v54, v54
  v_exp_f32 v55, v55
  v_pk_mul_f32 v[56:57], v[56:57], v[178:179] op_sel_hi:[1,0]
  v_pk_mul_f32 v[58:59], v[58:59], v[178:179] op_sel_hi:[1,0]
  v_pk_mul_f32 v[60:61], v[60:61], v[180:181] op_sel_hi:[1,0]
  v_pk_mul_f32 v[62:63], v[62:63], v[180:181] op_sel_hi:[1,0]
  v_pk_add_f32 v[48:49], v[48:49], v[186:187] op_sel_hi:[1,0]
  v_pk_add_f32 v[50:51], v[50:51], v[186:187] op_sel_hi:[1,0]
  v_pk_add_f32 v[52:53], v[52:53], v[186:187] op_sel_hi:[1,0]
  v_pk_add_f32 v[54:55], v[54:55], v[186:187] op_sel_hi:[1,0]
  v_rcp_f32 v48, v48
  v_rcp_f32 v49, v49
  v_rcp_f32 v50, v50
  v_rcp_f32 v51, v51
  v_rcp_f32 v52, v52
  v_rcp_f32 v53, v53
  v_rcp_f32 v54, v54
  v_rcp_f32 v55, v55
  v_pk_mul_f32 v[56:57], v[56:57], v[48:49]
  v_pk_mul_f32 v[58:59], v[58:59], v[50:51]
  v_pk_mul_f32 v[60:61], v[60:61], v[52:53]
  v_pk_mul_f32 v[62:63], v[62:63], v[54:55]
  v_cvt_pk_bf16_f32 v128, v56, v57
  v_cvt_pk_bf16_f32 v129, v58, v59
  v_cvt_pk_bf16_f32 v130, v60, v61
  v_cvt_pk_bf16_f32 v131, v62, v63
  s_nop 0
  v_permlane32_swap_b32 v128, v130
  v_permlane32_swap_b32 v129, v131
  buffer_store_dwordx4 v[128:131], v172, s[28:31], s66 offen offset:2048 sc1
  v_pk_mul_f32 v[64:65], v[64:65], v[182:183] op_sel_hi:[1,0]
  v_pk_mul_f32 v[66:67], v[66:67], v[182:183] op_sel_hi:[1,0]
  v_pk_mul_f32 v[68:69], v[68:69], v[184:185] op_sel_hi:[1,0]
  v_pk_mul_f32 v[70:71], v[70:71], v[184:185] op_sel_hi:[1,0]
  v_exp_f32 v64, v64
  v_exp_f32 v65, v65
  v_exp_f32 v66, v66
  v_exp_f32 v67, v67
  v_exp_f32 v68, v68
  v_exp_f32 v69, v69
  v_exp_f32 v70, v70
  v_exp_f32 v71, v71
  v_pk_mul_f32 v[72:73], v[72:73], v[178:179] op_sel_hi:[1,0]
  v_pk_mul_f32 v[74:75], v[74:75], v[178:179] op_sel_hi:[1,0]
  v_pk_mul_f32 v[76:77], v[76:77], v[180:181] op_sel_hi:[1,0]
  v_pk_mul_f32 v[78:79], v[78:79], v[180:181] op_sel_hi:[1,0]
  v_pk_add_f32 v[64:65], v[64:65], v[186:187] op_sel_hi:[1,0]
  v_pk_add_f32 v[66:67], v[66:67], v[186:187] op_sel_hi:[1,0]
  v_pk_add_f32 v[68:69], v[68:69], v[186:187] op_sel_hi:[1,0]
  v_pk_add_f32 v[70:71], v[70:71], v[186:187] op_sel_hi:[1,0]
  v_rcp_f32 v64, v64
  v_rcp_f32 v65, v65
  v_rcp_f32 v66, v66
  v_rcp_f32 v67, v67
  v_rcp_f32 v68, v68
  v_rcp_f32 v69, v69
  v_rcp_f32 v70, v70
  v_rcp_f32 v71, v71
  v_pk_mul_f32 v[72:73], v[72:73], v[64:65]
  v_pk_mul_f32 v[74:75], v[74:75], v[66:67]
  v_pk_mul_f32 v[76:77], v[76:77], v[68:69]
  v_pk_mul_f32 v[78:79], v[78:79], v[70:71]
  v_cvt_pk_bf16_f32 v132, v72, v73
  v_cvt_pk_bf16_f32 v133, v74, v75
  v_cvt_pk_bf16_f32 v134, v76, v77
  v_cvt_pk_bf16_f32 v135, v78, v79
  s_nop 0
  v_permlane32_swap_b32 v132, v134
  v_permlane32_swap_b32 v133, v135
  buffer_store_dwordx4 v[132:135], v172, s[28:31], s66 offen offset:3072 sc1
  v_pk_mul_f32 v[80:81], v[80:81], v[182:183] op_sel_hi:[1,0]
  v_pk_mul_f32 v[82:83], v[82:83], v[182:183] op_sel_hi:[1,0]
  v_pk_mul_f32 v[84:85], v[84:85], v[184:185] op_sel_hi:[1,0]
  v_pk_mul_f32 v[86:87], v[86:87], v[184:185] op_sel_hi:[1,0]
  v_exp_f32 v80, v80
  v_exp_f32 v81, v81
  v_exp_f32 v82, v82
  v_exp_f32 v83, v83
  v_exp_f32 v84, v84
  v_exp_f32 v85, v85
  v_exp_f32 v86, v86
  v_exp_f32 v87, v87
  v_pk_mul_f32 v[88:89], v[88:89], v[178:179] op_sel_hi:[1,0]
  v_pk_mul_f32 v[90:91], v[90:91], v[178:179] op_sel_hi:[1,0]
  v_pk_mul_f32 v[92:93], v[92:93], v[180:181] op_sel_hi:[1,0]
  v_pk_mul_f32 v[94:95], v[94:95], v[180:181] op_sel_hi:[1,0]
  v_pk_add_f32 v[80:81], v[80:81], v[186:187] op_sel_hi:[1,0]
  v_pk_add_f32 v[82:83], v[82:83], v[186:187] op_sel_hi:[1,0]
  v_pk_add_f32 v[84:85], v[84:85], v[186:187] op_sel_hi:[1,0]
  v_pk_add_f32 v[86:87], v[86:87], v[186:187] op_sel_hi:[1,0]
  v_rcp_f32 v80, v80
  v_rcp_f32 v81, v81
  v_rcp_f32 v82, v82
  v_rcp_f32 v83, v83
  v_rcp_f32 v84, v84
  v_rcp_f32 v85, v85
  v_rcp_f32 v86, v86
  v_rcp_f32 v87, v87
  v_pk_mul_f32 v[88:89], v[88:89], v[80:81]
  v_pk_mul_f32 v[90:91], v[90:91], v[82:83]
  v_pk_mul_f32 v[92:93], v[92:93], v[84:85]
  v_pk_mul_f32 v[94:95], v[94:95], v[86:87]
  v_cvt_pk_bf16_f32 v128, v88, v89
  v_cvt_pk_bf16_f32 v129, v90, v91
  v_cvt_pk_bf16_f32 v130, v92, v93
  v_cvt_pk_bf16_f32 v131, v94, v95
  s_nop 0
  v_permlane32_swap_b32 v128, v130
  v_permlane32_swap_b32 v129, v131
  buffer_store_dwordx4 v[128:131], v172, s[28:31], s68 offen offset:0 sc1
  v_pk_mul_f32 v[96:97], v[96:97], v[182:183] op_sel_hi:[1,0]
  v_pk_mul_f32 v[98:99], v[98:99], v[182:183] op_sel_hi:[1,0]
  v_pk_mul_f32 v[100:101], v[100:101], v[184:185] op_sel_hi:[1,0]
  v_pk_mul_f32 v[102:103], v[102:103], v[184:185] op_sel_hi:[1,0]
  v_exp_f32 v96, v96
  v_exp_f32 v97, v97
  v_exp_f32 v98, v98
  v_exp_f32 v99, v99
  v_exp_f32 v100, v100
  v_exp_f32 v101, v101
  v_exp_f32 v102, v102
  v_exp_f32 v103, v103
  v_pk_mul_f32 v[104:105], v[104:105], v[178:179] op_sel_hi:[1,0]
  v_pk_mul_f32 v[106:107], v[106:107], v[178:179] op_sel_hi:[1,0]
  v_pk_mul_f32 v[108:109], v[108:109], v[180:181] op_sel_hi:[1,0]
  v_pk_mul_f32 v[110:111], v[110:111], v[180:181] op_sel_hi:[1,0]
  v_pk_add_f32 v[96:97], v[96:97], v[186:187] op_sel_hi:[1,0]
  v_pk_add_f32 v[98:99], v[98:99], v[186:187] op_sel_hi:[1,0]
  v_pk_add_f32 v[100:101], v[100:101], v[186:187] op_sel_hi:[1,0]
  v_pk_add_f32 v[102:103], v[102:103], v[186:187] op_sel_hi:[1,0]
  v_rcp_f32 v96, v96
  v_rcp_f32 v97, v97
  v_rcp_f32 v98, v98
  v_rcp_f32 v99, v99
  v_rcp_f32 v100, v100
  v_rcp_f32 v101, v101
  v_rcp_f32 v102, v102
  v_rcp_f32 v103, v103
  v_pk_mul_f32 v[104:105], v[104:105], v[96:97]
  v_pk_mul_f32 v[106:107], v[106:107], v[98:99]
  v_pk_mul_f32 v[108:109], v[108:109], v[100:101]
  v_pk_mul_f32 v[110:111], v[110:111], v[102:103]
  v_cvt_pk_bf16_f32 v132, v104, v105
  v_cvt_pk_bf16_f32 v133, v106, v107
  v_cvt_pk_bf16_f32 v134, v108, v109
  v_cvt_pk_bf16_f32 v135, v110, v111
  s_nop 0
  v_permlane32_swap_b32 v132, v134
  v_permlane32_swap_b32 v133, v135
  buffer_store_dwordx4 v[132:135], v172, s[28:31], s68 offen offset:1024 sc1
  v_pk_mul_f32 v[112:113], v[112:113], v[182:183] op_sel_hi:[1,0]
  v_pk_mul_f32 v[114:115], v[114:115], v[182:183] op_sel_hi:[1,0]
  v_pk_mul_f32 v[116:117], v[116:117], v[184:185] op_sel_hi:[1,0]
  v_pk_mul_f32 v[118:119], v[118:119], v[184:185] op_sel_hi:[1,0]
  v_exp_f32 v112, v112
  v_exp_f32 v113, v113
  v_exp_f32 v114, v114
  v_exp_f32 v115, v115
  v_exp_f32 v116, v116
  v_exp_f32 v117, v117
  v_exp_f32 v118, v118
  v_exp_f32 v119, v119
  v_pk_mul_f32 v[120:121], v[120:121], v[178:179] op_sel_hi:[1,0]
  v_pk_mul_f32 v[122:123], v[122:123], v[178:179] op_sel_hi:[1,0]
  v_pk_mul_f32 v[124:125], v[124:125], v[180:181] op_sel_hi:[1,0]
  v_pk_mul_f32 v[126:127], v[126:127], v[180:181] op_sel_hi:[1,0]
  v_pk_add_f32 v[112:113], v[112:113], v[186:187] op_sel_hi:[1,0]
  v_pk_add_f32 v[114:115], v[114:115], v[186:187] op_sel_hi:[1,0]
  v_pk_add_f32 v[116:117], v[116:117], v[186:187] op_sel_hi:[1,0]
  v_pk_add_f32 v[118:119], v[118:119], v[186:187] op_sel_hi:[1,0]
  v_rcp_f32 v112, v112
  v_rcp_f32 v113, v113
  v_rcp_f32 v114, v114
  v_rcp_f32 v115, v115
  v_rcp_f32 v116, v116
  v_rcp_f32 v117, v117
  v_rcp_f32 v118, v118
  v_rcp_f32 v119, v119
  v_pk_mul_f32 v[120:121], v[120:121], v[112:113]
  v_pk_mul_f32 v[122:123], v[122:123], v[114:115]
  v_pk_mul_f32 v[124:125], v[124:125], v[116:117]
  v_pk_mul_f32 v[126:127], v[126:127], v[118:119]
  v_cvt_pk_bf16_f32 v128, v120, v121
  v_cvt_pk_bf16_f32 v129, v122, v123
  v_cvt_pk_bf16_f32 v130, v124, v125
  v_cvt_pk_bf16_f32 v131, v126, v127
  s_nop 0
  v_permlane32_swap_b32 v128, v130
  v_permlane32_swap_b32 v129, v131
  buffer_store_dwordx4 v[128:131], v172, s[28:31], s68 offen offset:2048 sc1
  s_waitcnt vmcnt(0)
  s_barrier
  v_and_b32 v179, 15, v0
  v_lshrrev_b32 v180, 2, v179
  v_lshl_add_u32 v180, v3, 2, v180
  v_lshlrev_b32 v180, 7, v180
  v_add_u32 v180, s53, v180
  v_and_b32 v181, 1, v0
  v_lshl_add_u32 v180, v181, 3, v180
  v_bfe_u32 v181, v0, 1, 1
  v_bfe_u32 v182, v0, 4, 1
  v_lshl_add_u32 v181, v182, 1, v181
  v_bfe_u32 v182, v0, 3, 1
  v_lshlrev_b32 v182, 2, v182
  v_xor_b32 v181, v181, v182
  s_and_b32 s47, s38, 1
  s_lshl_b32 s47, s47, 2
  v_xor_b32 v182, s47, v181
  v_lshl_add_u32 v160, v182, 4, v180
  v_add_u32 v161, 0x10000, v160
  v_add_u32 v162, 0x20000, v160
  v_xor_b32 v182, s47, v181
  v_xor_b32 v182, 4, v182
  v_lshl_add_u32 v163, v182, 4, v180
  v_add_u32 v164, 0x10000, v163
  v_add_u32 v165, 0x20000, v163
  v_add_u32 v166, s53, v2
  v_add_u32 v167, 0x10000, v166
  v_add_u32 v168, 0x20000, v166
  v_xor_b32 v169, 1024, v166
  v_add_u32 v170, 0x10000, v169
  v_add_u32 v171, 0x20000, v169
  v_xor_b32 v172, 2048, v166
  v_add_u32 v173, 0x10000, v172
  v_add_u32 v174, 0x20000, v172
  v_xor_b32 v175, 3072, v166
  v_add_u32 v176, 0x10000, v175
  v_add_u32 v177, 0x20000, v175
  s_lshr_b32 s47, s38, 1
  s_xor_b32 s47, s47, 0
  s_add_u32 s47, s47, s62
  s_mul_i32 s47, s47, 112
  s_mul_i32 s48, s38, 28
  s_add_u32 s47, s47, s48
  s_lshl_b32 s47, s47, 10
  s_add_u32 s66, s47, 4194304
  s_lshr_b32 s47, s38, 1
  s_xor_b32 s47, s47, 1
  s_add_u32 s47, s47, s62
  s_mul_i32 s47, s47, 112
  s_mul_i32 s48, s38, 28
  s_add_u32 s47, s47, s48
  s_lshl_b32 s47, s47, 10
  s_add_u32 s68, s47, 4194304
  s_lshr_b32 s47, s38, 1
  s_add_u32 s47, s47, s62
  s_lshl_b32 s47, s47, 15
  s_and_b32 s48, s38, 1
  s_lshl_b32 s48, s48, 6
  s_add_u32 s47, s47, s48
  s_lshl_b32 s48, s63, 7
  s_add_u32 s59, s47, s48
  v_lshlrev_b32 v14, 4, v3
  v_lshl_add_u32 v14, v1, 10, v14
  v_lshlrev_b32 v144, 16, v4
  v_and_b32 v145, 0xffff0000, v4
  v_lshlrev_b32 v146, 16, v5
  v_and_b32 v147, 0xffff0000, v5
  v_lshlrev_b32 v148, 16, v6
  v_and_b32 v149, 0xffff0000, v6
  v_lshlrev_b32 v150, 16, v7
  v_and_b32 v151, 0xffff0000, v7
  v_lshlrev_b32 v152, 16, v8
  v_and_b32 v153, 0xffff0000, v8
  v_lshlrev_b32 v154, 16, v9
  v_and_b32 v155, 0xffff0000, v9
  v_lshlrev_b32 v156, 16, v10
  v_and_b32 v157, 0xffff0000, v10
  v_lshlrev_b32 v158, 16, v11
  v_and_b32 v159, 0xffff0000, v11
  s_waitcnt vmcnt(0)
  s_barrier
  buffer_load_dwordx4 a[0:3], v2, s[28:31], s66 offen offset:0 sc1
  buffer_load_dwordx4 a[4:7], v2, s[28:31], s68 offen offset:0 sc1
  buffer_load_dwordx4 a[8:11], v2, s[28:31], s66 offen offset:1024 sc1
  buffer_load_dwordx4 a[12:15], v2, s[28:31], s68 offen offset:1024 sc1
  buffer_load_dwordx4 a[16:19], v2, s[28:31], s66 offen offset:2048 sc1
  buffer_load_dwordx4 a[20:23], v2, s[28:31], s68 offen offset:2048 sc1
  buffer_load_dwordx4 a[24:27], v2, s[28:31], s66 offen offset:3072 sc1
  buffer_load_dwordx4 a[28:31], v2, s[28:31], s68 offen offset:3072 sc1
  ds_read_b64_tr_b16 v[112:113], v160 offset:0
  ds_read_b64_tr_b16 v[114:115], v160 offset:4096
  ds_read_b64_tr_b16 v[116:117], v163 offset:0
  ds_read_b64_tr_b16 v[118:119], v163 offset:4096
  s_waitcnt vmcnt(6)
  s_waitcnt lgkmcnt(2)
  v_mfma_f32_32x32x16_bf16 v[16:31], v[112:115], a[0:3], 0
  ds_read_b64_tr_b16 v[120:121], v160 offset:8192
  v_mfma_f32_32x32x16_bf16 v[48:63], v[112:115], a[4:7], 0
  ds_read_b64_tr_b16 v[122:123], v160 offset:12288
  s_add_u32 s66, s66, 4096
  buffer_load_dwordx4 a[32:35], v2, s[28:31], s66 offen offset:0 sc1
  s_add_u32 s68, s68, 4096
  buffer_load_dwordx4 a[36:39], v2, s[28:31], s68 offen offset:0 sc1
  s_waitcnt lgkmcnt(2)
  v_mfma_f32_32x32x16_bf16 v[32:47], v[116:119], a[0:3], 0
  ds_read_b64_tr_b16 v[124:125], v163 offset:8192
  v_mfma_f32_32x32x16_bf16 v[64:79], v[116:119], a[4:7], 0
  ds_read_b64_tr_b16 v[126:127], v163 offset:12288
  buffer_load_dwordx4 a[40:43], v2, s[28:31], s66 offen offset:1024 sc1
  buffer_load_dwordx4 a[44:47], v2, s[28:31], s68 offen offset:1024 sc1
  s_waitcnt vmcnt(8)
  s_waitcnt lgkmcnt(2)
  v_mfma_f32_32x32x16_bf16 v[16:31], v[120:123], a[8:11], v[16:31]
  ds_read_b64_tr_b16 v[112:113], v160 offset:16384
  v_mfma_f32_32x32x16_bf16 v[48:63], v[120:123], a[12:15], v[48:63]
  ds_read_b64_tr_b16 v[114:115], v160 offset:20480
  buffer_load_dwordx4 a[48:51], v2, s[28:31], s66 offen offset:2048 sc1
  buffer_load_dwordx4 a[52:55], v2, s[28:31], s68 offen offset:2048 sc1
  s_waitcnt lgkmcnt(2)
  v_mfma_f32_32x32x16_bf16 v[32:47], v[124:127], a[8:11], v[32:47]
  ds_read_b64_tr_b16 v[116:117], v163 offset:16384
  v_mfma_f32_32x32x16_bf16 v[64:79], v[124:127], a[12:15], v[64:79]
  ds_read_b64_tr_b16 v[118:119], v163 offset:20480
  buffer_load_dwordx4 a[56:59], v2, s[28:31], s66 offen offset:3072 sc1
  buffer_load_dwordx4 a[60:63], v2, s[28:31], s68 offen offset:3072 sc1
  s_waitcnt vmcnt(10)
  s_waitcnt lgkmcnt(2)
  v_mfma_f32_32x32x16_bf16 v[16:31], v[112:115], a[16:19], v[16:31]
  ds_read_b64_tr_b16 v[120:121], v160 offset:24576
  v_mfma_f32_32x32x16_bf16 v[48:63], v[112:115], a[20:23], v[48:63]
  ds_read_b64_tr_b16 v[122:123], v160 offset:28800
  s_add_u32 s66, s66, 4096
  buffer_load_dwordx4 v[80:83], v2, s[28:31], s66 offen offset:0 sc1
  s_add_u32 s68, s68, 4096
  buffer_load_dwordx4 v[84:87], v2, s[28:31], s68 offen offset:0 sc1
  s_waitcnt lgkmcnt(2)
  v_mfma_f32_32x32x16_bf16 v[32:47], v[116:119], a[16:19], v[32:47]
  ds_read_b64_tr_b16 v[124:125], v163 offset:24576
  v_mfma_f32_32x32x16_bf16 v[64:79], v[116:119], a[20:23], v[64:79]
  ds_read_b64_tr_b16 v[126:127], v163 offset:28800
  s_waitcnt vmcnt(10)
  s_waitcnt lgkmcnt(2)
  v_mfma_f32_32x32x16_bf16 v[16:31], v[120:123], a[24:27], v[16:31]
  ds_read_b64_tr_b16 v[112:113], v160 offset:32896
  v_mfma_f32_32x32x16_bf16 v[48:63], v[120:123], a[28:31], v[48:63]
  ds_read_b64_tr_b16 v[114:115], v160 offset:36992
  buffer_load_dwordx4 v[88:91], v2, s[28:31], s66 offen offset:1024 sc1
  buffer_load_dwordx4 v[92:95], v2, s[28:31], s68 offen offset:1024 sc1
  s_waitcnt lgkmcnt(2)
  v_mfma_f32_32x32x16_bf16 v[32:47], v[124:127], a[24:27], v[32:47]
  ds_read_b64_tr_b16 v[116:117], v163 offset:32896
  v_mfma_f32_32x32x16_bf16 v[64:79], v[124:127], a[28:31], v[64:79]
  ds_read_b64_tr_b16 v[118:119], v163 offset:36992
  s_waitcnt vmcnt(10)
  s_waitcnt lgkmcnt(2)
  v_mfma_f32_32x32x16_bf16 v[16:31], v[112:115], a[32:35], v[16:31]
  ds_read_b64_tr_b16 v[120:121], v160 offset:41088
  v_mfma_f32_32x32x16_bf16 v[48:63], v[112:115], a[36:39], v[48:63]
  ds_read_b64_tr_b16 v[122:123], v160 offset:45184
  buffer_load_dwordx4 v[96:99], v2, s[28:31], s66 offen offset:2048 sc1
  buffer_load_dwordx4 v[100:103], v2, s[28:31], s68 offen offset:2048 sc1
  s_waitcnt lgkmcnt(2)
  v_mfma_f32_32x32x16_bf16 v[32:47], v[116:119], a[32:35], v[32:47]
  ds_read_b64_tr_b16 v[124:125], v163 offset:41088
  v_mfma_f32_32x32x16_bf16 v[64:79], v[116:119], a[36:39], v[64:79]
  ds_read_b64_tr_b16 v[126:127], v163 offset:45184
  s_waitcnt vmcnt(10)
  s_waitcnt lgkmcnt(2)
  v_mfma_f32_32x32x16_bf16 v[16:31], v[120:123], a[40:43], v[16:31]
  ds_read_b64_tr_b16 v[112:113], v160 offset:49280
  v_mfma_f32_32x32x16_bf16 v[48:63], v[120:123], a[44:47], v[48:63]
  ds_read_b64_tr_b16 v[114:115], v160 offset:53376
  buffer_load_dwordx4 v[104:107], v2, s[28:31], s66 offen offset:3072 sc1
  buffer_load_dwordx4 v[108:111], v2, s[28:31], s68 offen offset:3072 sc1
  s_waitcnt lgkmcnt(2)
  v_mfma_f32_32x32x16_bf16 v[32:47], v[124:127], a[40:43], v[32:47]
  ds_read_b64_tr_b16 v[116:117], v163 offset:49280
  v_mfma_f32_32x32x16_bf16 v[64:79], v[124:127], a[44:47], v[64:79]
  ds_read_b64_tr_b16 v[118:119], v163 offset:53376
  s_barrier
  s_waitcnt vmcnt(10)
  s_waitcnt lgkmcnt(2)
  v_mfma_f32_32x32x16_bf16 v[16:31], v[112:115], a[48:51], v[16:31]
  ds_read_b64_tr_b16 v[120:121], v161 offset:0
  v_mfma_f32_32x32x16_bf16 v[48:63], v[112:115], a[52:55], v[48:63]
  ds_read_b64_tr_b16 v[122:123], v161 offset:4096
  s_add_u32 s66, s66, 4096
  buffer_load_dwordx4 v[128:131], v2, s[28:31], s66 offen offset:0 sc1
  s_add_u32 s68, s68, 4096
  buffer_load_dwordx4 v[132:135], v2, s[28:31], s68 offen offset:0 sc1
  s_waitcnt lgkmcnt(2)
  v_mfma_f32_32x32x16_bf16 v[32:47], v[116:119], a[48:51], v[32:47]
  ds_read_b64_tr_b16 v[124:125], v164 offset:0
  v_mfma_f32_32x32x16_bf16 v[64:79], v[116:119], a[52:55], v[64:79]
  ds_read_b64_tr_b16 v[126:127], v164 offset:4096
  s_waitcnt vmcnt(10)
  s_waitcnt lgkmcnt(2)
  v_mfma_f32_32x32x16_bf16 v[16:31], v[120:123], a[56:59], v[16:31]
  ds_read_b64_tr_b16 v[112:113], v161 offset:8192
  v_mfma_f32_32x32x16_bf16 v[48:63], v[120:123], a[60:63], v[48:63]
  ds_read_b64_tr_b16 v[114:115], v161 offset:12288
  buffer_load_dwordx4 v[136:139], v2, s[28:31], s66 offen offset:1024 sc1
  buffer_load_dwordx4 v[140:143], v2, s[28:31], s68 offen offset:1024 sc1
  s_waitcnt lgkmcnt(2)
  v_mfma_f32_32x32x16_bf16 v[32:47], v[124:127], a[56:59], v[32:47]
  ds_read_b64_tr_b16 v[116:117], v164 offset:8192
  v_mfma_f32_32x32x16_bf16 v[64:79], v[124:127], a[60:63], v[64:79]
  ds_read_b64_tr_b16 v[118:119], v164 offset:12288
  s_waitcnt vmcnt(10)
  s_waitcnt lgkmcnt(2)
  v_mfma_f32_32x32x16_bf16 v[16:31], v[112:115], v[80:83], v[16:31]
  ds_read_b64_tr_b16 v[120:121], v161 offset:16384
  v_mfma_f32_32x32x16_bf16 v[48:63], v[112:115], v[84:87], v[48:63]
  ds_read_b64_tr_b16 v[122:123], v161 offset:20480
  buffer_load_dwordx4 a[0:3], v2, s[28:31], s66 offen offset:2048 sc1
  buffer_load_dwordx4 a[4:7], v2, s[28:31], s68 offen offset:2048 sc1
  s_waitcnt lgkmcnt(2)
  v_mfma_f32_32x32x16_bf16 v[32:47], v[116:119], v[80:83], v[32:47]
  ds_read_b64_tr_b16 v[124:125], v164 offset:16384
  v_mfma_f32_32x32x16_bf16 v[64:79], v[116:119], v[84:87], v[64:79]
  ds_read_b64_tr_b16 v[126:127], v164 offset:20480
  s_waitcnt vmcnt(10)
  s_waitcnt lgkmcnt(2)
  v_mfma_f32_32x32x16_bf16 v[16:31], v[120:123], v[88:91], v[16:31]
  ds_read_b64_tr_b16 v[112:113], v161 offset:24576
  v_mfma_f32_32x32x16_bf16 v[48:63], v[120:123], v[92:95], v[48:63]
  ds_read_b64_tr_b16 v[114:115], v161 offset:28800
  buffer_load_dwordx4 a[8:11], v2, s[28:31], s66 offen offset:3072 sc1
  buffer_load_dwordx4 a[12:15], v2, s[28:31], s68 offen offset:3072 sc1
  s_waitcnt lgkmcnt(2)
  v_mfma_f32_32x32x16_bf16 v[32:47], v[124:127], v[88:91], v[32:47]
  ds_read_b64_tr_b16 v[116:117], v164 offset:24576
  v_mfma_f32_32x32x16_bf16 v[64:79], v[124:127], v[92:95], v[64:79]
  ds_read_b64_tr_b16 v[118:119], v164 offset:28800
  s_waitcnt vmcnt(10)
  s_waitcnt lgkmcnt(2)
  v_mfma_f32_32x32x16_bf16 v[16:31], v[112:115], v[96:99], v[16:31]
  ds_read_b64_tr_b16 v[120:121], v161 offset:32896
  v_mfma_f32_32x32x16_bf16 v[48:63], v[112:115], v[100:103], v[48:63]
  ds_read_b64_tr_b16 v[122:123], v161 offset:36992
  s_add_u32 s66, s66, 4096
  buffer_load_dwordx4 a[16:19], v2, s[28:31], s66 offen offset:0 sc1
  s_add_u32 s68, s68, 4096
  buffer_load_dwordx4 a[20:23], v2, s[28:31], s68 offen offset:0 sc1
  s_waitcnt lgkmcnt(2)
  v_mfma_f32_32x32x16_bf16 v[32:47], v[116:119], v[96:99], v[32:47]
  ds_read_b64_tr_b16 v[124:125], v164 offset:32896
  v_mfma_f32_32x32x16_bf16 v[64:79], v[116:119], v[100:103], v[64:79]
  ds_read_b64_tr_b16 v[126:127], v164 offset:36992
  s_barrier
  s_waitcnt vmcnt(10)
  s_waitcnt lgkmcnt(2)
  v_mfma_f32_32x32x16_bf16 v[16:31], v[120:123], v[104:107], v[16:31]
  ds_read_b64_tr_b16 v[112:113], v161 offset:41088
  v_mfma_f32_32x32x16_bf16 v[48:63], v[120:123], v[108:111], v[48:63]
  ds_read_b64_tr_b16 v[114:115], v161 offset:45184
  buffer_load_dwordx4 a[24:27], v2, s[28:31], s66 offen offset:1024 sc1
  buffer_load_dwordx4 a[28:31], v2, s[28:31], s68 offen offset:1024 sc1
  s_waitcnt lgkmcnt(2)
  v_mfma_f32_32x32x16_bf16 v[32:47], v[124:127], v[104:107], v[32:47]
  ds_read_b64_tr_b16 v[116:117], v164 offset:41088
  v_mfma_f32_32x32x16_bf16 v[64:79], v[124:127], v[108:111], v[64:79]
  ds_read_b64_tr_b16 v[118:119], v164 offset:45184
  s_waitcnt vmcnt(10)
  s_waitcnt lgkmcnt(2)
  v_mfma_f32_32x32x16_bf16 v[16:31], v[112:115], v[128:131], v[16:31]
  ds_read_b64_tr_b16 v[120:121], v161 offset:49280
  v_mfma_f32_32x32x16_bf16 v[48:63], v[112:115], v[132:135], v[48:63]
  ds_read_b64_tr_b16 v[122:123], v161 offset:53376
  buffer_load_dwordx4 a[32:35], v2, s[28:31], s66 offen offset:2048 sc1
  buffer_load_dwordx4 a[36:39], v2, s[28:31], s68 offen offset:2048 sc1
  s_waitcnt lgkmcnt(2)
  v_mfma_f32_32x32x16_bf16 v[32:47], v[116:119], v[128:131], v[32:47]
  ds_read_b64_tr_b16 v[124:125], v164 offset:49280
  v_mfma_f32_32x32x16_bf16 v[64:79], v[116:119], v[132:135], v[64:79]
  ds_read_b64_tr_b16 v[126:127], v164 offset:53376
  s_waitcnt vmcnt(10)
  s_waitcnt lgkmcnt(2)
  v_mfma_f32_32x32x16_bf16 v[16:31], v[120:123], v[136:139], v[16:31]
  ds_read_b64_tr_b16 v[112:113], v161 offset:57600
  v_mfma_f32_32x32x16_bf16 v[48:63], v[120:123], v[140:143], v[48:63]
  ds_read_b64_tr_b16 v[114:115], v161 offset:61696
  buffer_load_dwordx4 a[40:43], v2, s[28:31], s66 offen offset:3072 sc1
  buffer_load_dwordx4 a[44:47], v2, s[28:31], s68 offen offset:3072 sc1
  s_waitcnt lgkmcnt(2)
  v_mfma_f32_32x32x16_bf16 v[32:47], v[124:127], v[136:139], v[32:47]
  ds_read_b64_tr_b16 v[116:117], v164 offset:57600
  v_mfma_f32_32x32x16_bf16 v[64:79], v[124:127], v[140:143], v[64:79]
  ds_read_b64_tr_b16 v[118:119], v164 offset:61696
  s_waitcnt vmcnt(10)
  s_waitcnt lgkmcnt(2)
  v_mfma_f32_32x32x16_bf16 v[16:31], v[112:115], a[0:3], v[16:31]
  ds_read_b64_tr_b16 v[120:121], v162 offset:256
  v_mfma_f32_32x32x16_bf16 v[48:63], v[112:115], a[4:7], v[48:63]
  ds_read_b64_tr_b16 v[122:123], v162 offset:4352
  s_add_u32 s66, s66, 4096
  buffer_load_dwordx4 a[48:51], v2, s[28:31], s66 offen offset:0 sc1
  s_add_u32 s68, s68, 4096
  buffer_load_dwordx4 a[52:55], v2, s[28:31], s68 offen offset:0 sc1
  s_waitcnt lgkmcnt(2)
  v_mfma_f32_32x32x16_bf16 v[32:47], v[116:119], a[0:3], v[32:47]
  ds_read_b64_tr_b16 v[124:125], v165 offset:256
  v_mfma_f32_32x32x16_bf16 v[64:79], v[116:119], a[4:7], v[64:79]
  ds_read_b64_tr_b16 v[126:127], v165 offset:4352
  s_waitcnt vmcnt(10)
  s_waitcnt lgkmcnt(2)
  v_mfma_f32_32x32x16_bf16 v[16:31], v[120:123], a[8:11], v[16:31]
  ds_read_b64_tr_b16 v[112:113], v162 offset:8448
  v_mfma_f32_32x32x16_bf16 v[48:63], v[120:123], a[12:15], v[48:63]
  ds_read_b64_tr_b16 v[114:115], v162 offset:12544
  buffer_load_dwordx4 a[56:59], v2, s[28:31], s66 offen offset:1024 sc1
  buffer_load_dwordx4 a[60:63], v2, s[28:31], s68 offen offset:1024 sc1
  s_waitcnt lgkmcnt(2)
  v_mfma_f32_32x32x16_bf16 v[32:47], v[124:127], a[8:11], v[32:47]
  ds_read_b64_tr_b16 v[116:117], v165 offset:8448
  v_mfma_f32_32x32x16_bf16 v[64:79], v[124:127], a[12:15], v[64:79]
  ds_read_b64_tr_b16 v[118:119], v165 offset:12544
  s_barrier
  s_waitcnt vmcnt(10)
  s_waitcnt lgkmcnt(2)
  v_mfma_f32_32x32x16_bf16 v[16:31], v[112:115], a[16:19], v[16:31]
  ds_read_b64_tr_b16 v[120:121], v162 offset:16640
  v_mfma_f32_32x32x16_bf16 v[48:63], v[112:115], a[20:23], v[48:63]
  ds_read_b64_tr_b16 v[122:123], v160 offset:0
  buffer_load_dwordx4 v[80:83], v2, s[28:31], s66 offen offset:2048 sc1
  buffer_load_dwordx4 v[84:87], v2, s[28:31], s68 offen offset:2048 sc1
  s_waitcnt lgkmcnt(2)
  v_mfma_f32_32x32x16_bf16 v[32:47], v[116:119], a[16:19], v[32:47]
  ds_read_b64_tr_b16 v[124:125], v165 offset:16640
  v_mfma_f32_32x32x16_bf16 v[64:79], v[116:119], a[20:23], v[64:79]
  ds_read_b64_tr_b16 v[126:127], v163 offset:0
  s_waitcnt vmcnt(10)
  s_waitcnt lgkmcnt(2)
  v_mfma_f32_32x32x16_bf16 v[16:31], v[120:123], a[24:27], v[16:31]
  ds_read_b64_tr_b16 v[112:113], v160 offset:4096
  v_mfma_f32_32x32x16_bf16 v[48:63], v[120:123], a[28:31], v[48:63]
  ds_read_b64_tr_b16 v[114:115], v160 offset:8192
  buffer_load_dwordx4 v[88:91], v2, s[28:31], s66 offen offset:3072 sc1
  buffer_load_dwordx4 v[92:95], v2, s[28:31], s68 offen offset:3072 sc1
  s_waitcnt lgkmcnt(2)
  v_mfma_f32_32x32x16_bf16 v[32:47], v[124:127], a[24:27], v[32:47]
  ds_read_b64_tr_b16 v[116:117], v163 offset:4096
  v_mfma_f32_32x32x16_bf16 v[64:79], v[124:127], a[28:31], v[64:79]
  ds_read_b64_tr_b16 v[118:119], v163 offset:8192
  s_waitcnt vmcnt(10)
  s_waitcnt lgkmcnt(2)
  v_mfma_f32_32x32x16_bf16 v[16:31], v[112:115], a[32:35], v[16:31]
  ds_read_b64_tr_b16 v[120:121], v160 offset:12288
  v_mfma_f32_32x32x16_bf16 v[48:63], v[112:115], a[36:39], v[48:63]
  ds_read_b64_tr_b16 v[122:123], v160 offset:16384
  s_add_u32 s66, s66, 4096
  buffer_load_dwordx4 v[96:99], v2, s[28:31], s66 offen offset:0 sc1
  s_add_u32 s68, s68, 4096
  buffer_load_dwordx4 v[100:103], v2, s[28:31], s68 offen offset:0 sc1
  s_waitcnt lgkmcnt(2)
  v_mfma_f32_32x32x16_bf16 v[32:47], v[116:119], a[32:35], v[32:47]
  ds_read_b64_tr_b16 v[124:125], v163 offset:12288
  v_mfma_f32_32x32x16_bf16 v[64:79], v[116:119], a[36:39], v[64:79]
  ds_read_b64_tr_b16 v[126:127], v163 offset:16384
  s_waitcnt vmcnt(10)
  s_waitcnt lgkmcnt(2)
  v_mfma_f32_32x32x16_bf16 v[16:31], v[120:123], a[40:43], v[16:31]
  ds_read_b64_tr_b16 v[112:113], v160 offset:20480
  v_mfma_f32_32x32x16_bf16 v[48:63], v[120:123], a[44:47], v[48:63]
  ds_read_b64_tr_b16 v[114:115], v160 offset:24576
  buffer_load_dwordx4 v[104:107], v2, s[28:31], s66 offen offset:1024 sc1
  buffer_load_dwordx4 v[108:111], v2, s[28:31], s68 offen offset:1024 sc1
  s_waitcnt lgkmcnt(2)
  v_mfma_f32_32x32x16_bf16 v[32:47], v[124:127], a[40:43], v[32:47]
  ds_read_b64_tr_b16 v[116:117], v163 offset:20480
  v_mfma_f32_32x32x16_bf16 v[64:79], v[124:127], a[44:47], v[64:79]
  ds_read_b64_tr_b16 v[118:119], v163 offset:24576
  s_waitcnt vmcnt(10)
  s_waitcnt lgkmcnt(2)
  v_mfma_f32_32x32x16_bf16 v[16:31], v[112:115], a[48:51], v[16:31]
  ds_read_b64_tr_b16 v[120:121], v160 offset:28800
  v_mfma_f32_32x32x16_bf16 v[48:63], v[112:115], a[52:55], v[48:63]
  ds_read_b64_tr_b16 v[122:123], v160 offset:32896
  buffer_load_dwordx4 v[128:131], v2, s[28:31], s66 offen offset:2048 sc1
  buffer_load_dwordx4 v[132:135], v2, s[28:31], s68 offen offset:2048 sc1
  s_waitcnt lgkmcnt(2)
  v_mfma_f32_32x32x16_bf16 v[32:47], v[116:119], a[48:51], v[32:47]
  ds_read_b64_tr_b16 v[124:125], v163 offset:28800
  v_mfma_f32_32x32x16_bf16 v[64:79], v[116:119], a[52:55], v[64:79]
  ds_read_b64_tr_b16 v[126:127], v163 offset:32896
  s_waitcnt vmcnt(10)
  s_waitcnt lgkmcnt(2)
  v_mfma_f32_32x32x16_bf16 v[16:31], v[120:123], a[56:59], v[16:31]
  ds_read_b64_tr_b16 v[112:113], v160 offset:36992
  v_mfma_f32_32x32x16_bf16 v[48:63], v[120:123], a[60:63], v[48:63]
  ds_read_b64_tr_b16 v[114:115], v160 offset:41088
  buffer_load_dwordx4 v[136:139], v2, s[28:31], s66 offen offset:3072 sc1
  buffer_load_dwordx4 v[140:143], v2, s[28:31], s68 offen offset:3072 sc1
  s_waitcnt lgkmcnt(2)
  v_mfma_f32_32x32x16_bf16 v[32:47], v[124:127], a[56:59], v[32:47]
  ds_read_b64_tr_b16 v[116:117], v163 offset:36992
  v_mfma_f32_32x32x16_bf16 v[64:79], v[124:127], a[60:63], v[64:79]
  ds_read_b64_tr_b16 v[118:119], v163 offset:41088
  s_waitcnt vmcnt(10)
  s_waitcnt lgkmcnt(2)
  v_mfma_f32_32x32x16_bf16 v[16:31], v[112:115], v[80:83], v[16:31]
  ds_read_b64_tr_b16 v[120:121], v160 offset:45184
  v_mfma_f32_32x32x16_bf16 v[48:63], v[112:115], v[84:87], v[48:63]
  ds_read_b64_tr_b16 v[122:123], v160 offset:49280
  s_waitcnt lgkmcnt(2)
  v_mfma_f32_32x32x16_bf16 v[32:47], v[116:119], v[80:83], v[32:47]
  ds_read_b64_tr_b16 v[124:125], v163 offset:45184
  v_mfma_f32_32x32x16_bf16 v[64:79], v[116:119], v[84:87], v[64:79]
  ds_read_b64_tr_b16 v[126:127], v163 offset:49280
  s_waitcnt vmcnt(8)
  s_waitcnt lgkmcnt(2)
  v_mfma_f32_32x32x16_bf16 v[16:31], v[120:123], v[88:91], v[16:31]
  ds_read_b64_tr_b16 v[112:113], v160 offset:53376
  v_mfma_f32_32x32x16_bf16 v[48:63], v[120:123], v[92:95], v[48:63]
  ds_read_b64_tr_b16 v[114:115], v161 offset:0
  s_waitcnt lgkmcnt(2)
  v_mfma_f32_32x32x16_bf16 v[32:47], v[124:127], v[88:91], v[32:47]
  ds_read_b64_tr_b16 v[116:117], v163 offset:53376
  v_mfma_f32_32x32x16_bf16 v[64:79], v[124:127], v[92:95], v[64:79]
  ds_read_b64_tr_b16 v[118:119], v164 offset:0
  s_waitcnt vmcnt(6)
  s_waitcnt lgkmcnt(2)
  v_mfma_f32_32x32x16_bf16 v[16:31], v[112:115], v[96:99], v[16:31]
  ds_read_b64_tr_b16 v[120:121], v161 offset:4096
  v_mfma_f32_32x32x16_bf16 v[48:63], v[112:115], v[100:103], v[48:63]
  ds_read_b64_tr_b16 v[122:123], v161 offset:8192
  s_waitcnt lgkmcnt(2)
  v_mfma_f32_32x32x16_bf16 v[32:47], v[116:119], v[96:99], v[32:47]
  ds_read_b64_tr_b16 v[124:125], v164 offset:4096
  v_mfma_f32_32x32x16_bf16 v[64:79], v[116:119], v[100:103], v[64:79]
  ds_read_b64_tr_b16 v[126:127], v164 offset:8192
  s_waitcnt vmcnt(4)
  s_waitcnt lgkmcnt(2)
  v_mfma_f32_32x32x16_bf16 v[16:31], v[120:123], v[104:107], v[16:31]
  ds_read_b64_tr_b16 v[112:113], v161 offset:12288
  v_mfma_f32_32x32x16_bf16 v[48:63], v[120:123], v[108:111], v[48:63]
  ds_read_b64_tr_b16 v[114:115], v161 offset:16384
  s_waitcnt lgkmcnt(2)
  v_mfma_f32_32x32x16_bf16 v[32:47], v[124:127], v[104:107], v[32:47]
  ds_read_b64_tr_b16 v[116:117], v164 offset:12288
  v_mfma_f32_32x32x16_bf16 v[64:79], v[124:127], v[108:111], v[64:79]
  ds_read_b64_tr_b16 v[118:119], v164 offset:16384
  s_waitcnt vmcnt(2)
  s_waitcnt lgkmcnt(2)
  v_mfma_f32_32x32x16_bf16 v[16:31], v[112:115], v[128:131], v[16:31]
  ds_read_b64_tr_b16 v[120:121], v161 offset:20480
  v_mfma_f32_32x32x16_bf16 v[48:63], v[112:115], v[132:135], v[48:63]
  ds_read_b64_tr_b16 v[122:123], v161 offset:24576
  s_waitcnt lgkmcnt(2)
  v_mfma_f32_32x32x16_bf16 v[32:47], v[116:119], v[128:131], v[32:47]
  ds_read_b64_tr_b16 v[124:125], v164 offset:20480
  v_mfma_f32_32x32x16_bf16 v[64:79], v[116:119], v[132:135], v[64:79]
  ds_read_b64_tr_b16 v[126:127], v164 offset:24576
  s_waitcnt vmcnt(0)
  s_waitcnt lgkmcnt(2)
  v_mfma_f32_32x32x16_bf16 v[16:31], v[120:123], v[136:139], v[16:31]
  v_mfma_f32_32x32x16_bf16 v[48:63], v[120:123], v[140:143], v[48:63]
  s_waitcnt lgkmcnt(0)
  v_mfma_f32_32x32x16_bf16 v[32:47], v[124:127], v[136:139], v[32:47]
  v_mfma_f32_32x32x16_bf16 v[64:79], v[124:127], v[140:143], v[64:79]
  s_nop 10
  ds_write_b128 v166, v[32:35] offset:0
  ds_write_b128 v166, v[36:39] offset:4096
  ds_write_b128 v166, v[40:43] offset:8192
  ds_write_b128 v166, v[44:47] offset:12288
  ds_write_b128 v166, v[48:51] offset:16384
  ds_write_b128 v166, v[52:55] offset:20480
  ds_write_b128 v166, v[56:59] offset:24576
  ds_write_b128 v166, v[60:63] offset:28800
  ds_write_b128 v166, v[64:67] offset:32896
  ds_write_b128 v166, v[68:71] offset:36992
  ds_write_b128 v166, v[72:75] offset:41088
  ds_write_b128 v166, v[76:79] offset:45184
  v_pk_add_f32 v[16:17], v[16:17], v[144:145]
  v_pk_add_f32 v[18:19], v[18:19], v[146:147]
  v_pk_add_f32 v[20:21], v[20:21], v[148:149]
  v_pk_add_f32 v[22:23], v[22:23], v[150:151]
  v_pk_add_f32 v[24:25], v[24:25], v[152:153]
  v_pk_add_f32 v[26:27], v[26:27], v[154:155]
  v_pk_add_f32 v[28:29], v[28:29], v[156:157]
  v_pk_add_f32 v[30:31], v[30:31], v[158:159]
  s_waitcnt lgkmcnt(0)
  s_barrier
  ds_read_b128 v[32:35], v169 offset:0
  ds_read_b128 v[36:39], v169 offset:4096
  ds_read_b128 v[40:43], v169 offset:8192
  ds_read_b128 v[44:47], v169 offset:12288
  ds_read_b128 v[48:51], v172 offset:16384
  ds_read_b128 v[52:55], v172 offset:20480
  ds_read_b128 v[56:59], v172 offset:24576
  ds_read_b128 v[60:63], v172 offset:28800
  ds_read_b128 v[64:67], v175 offset:32896
  ds_read_b128 v[68:71], v175 offset:36992
  ds_read_b128 v[72:75], v175 offset:41088
  ds_read_b128 v[76:79], v175 offset:45184
  s_waitcnt lgkmcnt(8)
  v_pk_add_f32 v[16:17], v[16:17], v[32:33]
  v_pk_add_f32 v[18:19], v[18:19], v[34:35]
  v_pk_add_f32 v[20:21], v[20:21], v[36:37]
  v_pk_add_f32 v[22:23], v[22:23], v[38:39]
  v_pk_add_f32 v[24:25], v[24:25], v[40:41]
  v_pk_add_f32 v[26:27], v[26:27], v[42:43]
  v_pk_add_f32 v[28:29], v[28:29], v[44:45]
  v_pk_add_f32 v[30:31], v[30:31], v[46:47]
  s_waitcnt lgkmcnt(4)
  v_pk_add_f32 v[16:17], v[16:17], v[48:49]
  v_pk_add_f32 v[18:19], v[18:19], v[50:51]
  v_pk_add_f32 v[20:21], v[20:21], v[52:53]
  v_pk_add_f32 v[22:23], v[22:23], v[54:55]
  v_pk_add_f32 v[24:25], v[24:25], v[56:57]
  v_pk_add_f32 v[26:27], v[26:27], v[58:59]
  v_pk_add_f32 v[28:29], v[28:29], v[60:61]
  v_pk_add_f32 v[30:31], v[30:31], v[62:63]
  s_waitcnt lgkmcnt(0)
  v_pk_add_f32 v[16:17], v[16:17], v[64:65]
  v_pk_add_f32 v[18:19], v[18:19], v[66:67]
  v_pk_add_f32 v[20:21], v[20:21], v[68:69]
  v_pk_add_f32 v[22:23], v[22:23], v[70:71]
  v_pk_add_f32 v[24:25], v[24:25], v[72:73]
  v_pk_add_f32 v[26:27], v[26:27], v[74:75]
  v_pk_add_f32 v[28:29], v[28:29], v[76:77]
  v_pk_add_f32 v[30:31], v[30:31], v[78:79]
  v_cvt_pk_bf16_f32 v48, v16, v17
  v_cvt_pk_bf16_f32 v49, v18, v19
  v_cvt_pk_bf16_f32 v50, v20, v21
  v_cvt_pk_bf16_f32 v51, v22, v23
  v_cvt_pk_bf16_f32 v52, v24, v25
  v_cvt_pk_bf16_f32 v53, v26, v27
  v_cvt_pk_bf16_f32 v54, v28, v29
  v_cvt_pk_bf16_f32 v55, v30, v31
  v_permlane32_swap_b32 v48, v50
  v_permlane32_swap_b32 v49, v51
  v_permlane32_swap_b32 v52, v54
  v_permlane32_swap_b32 v53, v55
  buffer_store_dwordx4 v[48:51], v14, s[24:27], s59 offen
  buffer_store_dwordx4 v[52:55], v14, s[24:27], s59 offen offset:32
  s_waitcnt vmcnt(0)
L_end:
  s_endpgm
C_slow:
  s_waitcnt vmcnt(0)
  v_mov_b32 v187, 153616
  s_cmp_lg_u32 s38, 0
  s_cbranch_scc1 C_13
  s_lshl_b32 s50, s36, 5
  s_add_u32 s47, s50, s37
  v_mov_b32 v180, s47
  s_or_b32 s47, s40, 0xc0
  v_mov_b32 v181, s47
  v_and_b32 v182, 7, v0
  v_lshlrev_b32 v182, 2, v182
  s_mul_i32 s49, s40, 0x01010101
  s_or_b32 s48, s49, 0x40404040
  s_mov_b32 s59, 0
C_11:
  buffer_load_dword v183, v182, s[32:35], s50 offen sc1
  s_waitcnt vmcnt(0)
  v_and_b32 v184, 0x4f4f4f4f, v183
  v_cmp_ne_u32 vcc, s48, v184
  s_nop 0
  s_and_b32 vcc_lo, vcc_lo, 0xff
  s_cbranch_scc0 C_12
  s_add_u32 s59, s59, 1
  s_cmp_lt_u32 s59, 12
  s_cbranch_scc1 C_11
  buffer_wbl2 sc1
  s_waitcnt vmcnt(0)
  s_mov_b64 exec, 1
  buffer_store_byte v181, v180, s[32:35], 0 offen sc1
  s_mov_b64 exec, -1
C_10:
  buffer_load_dword v183, v182, s[32:35], s50 offen sc1
  s_waitcnt vmcnt(0)
  v_xor_b32 v184, s49, v183
  v_and_b32 v184, 0x0f0f0f0f, v184
  v_add_u32 v184, 0x0f0f0f0f, v184
  v_and_b32 v184, 0x10101010, v184
  v_xor_b32 v185, 0x10101010, v184
  v_lshrrev_b32 v186, 2, v183
  v_and_b32 v185, v185, v186
  v_lshrrev_b32 v186, 3, v183
  v_or_b32 v185, v185, v186
  v_and_b32 v185, 0x10101010, v185
  v_cmp_ne_u32 vcc, 0x10101010, v185
  s_nop 0
  s_and_b32 vcc_lo, vcc_lo, 0xff
  s_cbranch_scc1 C_10
  buffer_inv sc1
  s_waitcnt vmcnt(0)
C_12:
  v_mov_b32 v186, 1
  ds_write_b32 v187, v186
  s_waitcnt lgkmcnt(0)
  s_branch C_14
C_13:
  ds_read_b32 v186, v187
  s_waitcnt lgkmcnt(0)
  v_readfirstlane_b32 s47, v186
  s_sleep 2
  s_cmp_eq_u32 s47, 0
  s_cbranch_scc1 C_13
C_14:
  buffer_load_dwordx2 v[154:155], v151, s[28:31], 0 offen sc1
  buffer_load_dwordx2 v[156:157], v152, s[28:31], 0 offen sc1
  s_waitcnt vmcnt(0)
  s_branch C_ret
L_helper:
  s_getreg_b32 s40, hwreg(HW_REG_XCC_ID, 0, 4)
  s_lshl_b32 s45, s38, 9
  s_mul_i32 s46, s38, 3072
  s_add_u32 s46, s46, 18432
  v_lshrrev_b32 v40, 3, v0
  v_lshrrev_b32 v41, 4, v0
  v_and_b32 v42, 7, v0
  s_lshl_b32 s47, s38, 5
  s_add_u32 s47, s47, s51
  v_add_u32 v43, s47, v40
  v_lshlrev_b32 v43, 10, v43
  v_xor_b32 v44, v42, v41
  v_xor_b32 v45, 4, v44
  v_lshl_add_u32 v44, v44, 4, v43
  v_lshl_add_u32 v45, v45, 4, v43
  v_add_u32 v16, 0, v44
  v_add_u32 v17, 7168, v45
  v_add_u32 v18, 14336, v44
  v_add_u32 v19, 21504, v45
  s_lshl_b32 s47, s38, 2
  v_add_u32 v43, s47, v40
  v_lshrrev_b32 v44, 1, v43
  v_and_b32 v44, 7, v44
  v_xor_b32 v44, v42, v44
  s_sub_u32 s48, s51, 16
  v_add_u32 v43, s48, v43
  v_max_i32 v43, 0, v43
  v_lshlrev_b32 v43, 10, v43
  v_lshl_add_u32 v20, v44, 4, v43
  s_mul_i32 s47, s38, 49152
  s_lshl_b32 s48, s64, 6
  s_add_u32 s47, s47, s48
  v_add_u32 v43, 0, v0
  v_mul_u32_u24 v44, 43691, v43
  v_lshrrev_b32 v44, 19, v44
  v_mul_u32_u24 v45, 12, v44
  v_sub_u32 v45, v43, v45
  v_mul_u32_u24 v44, 3072, v44
  v_lshrrev_b32 v46, 2, v45
  v_lshl_add_u32 v44, v46, 10, v44
  v_and_b32 v45, 3, v45
  v_lshl_add_u32 v44, v45, 4, v44
  v_add_u32 v44, s47, v44
  v_mov_b32 v21, v44
  v_add_u32 v43, 64, v0
  v_mul_u32_u24 v44, 43691, v43
  v_lshrrev_b32 v44, 19, v44
  v_mul_u32_u24 v45, 12, v44
  v_sub_u32 v45, v43, v45
  v_mul_u32_u24 v44, 3072, v44
  v_lshrrev_b32 v46, 2, v45
  v_lshl_add_u32 v44, v46, 10, v44
  v_and_b32 v45, 3, v45
  v_lshl_add_u32 v44, v45, 4, v44
  v_add_u32 v44, s47, v44
  v_subrev_u32 v22, 1024, v44
  v_add_u32 v43, 128, v0
  v_mul_u32_u24 v44, 43691, v43
  v_lshrrev_b32 v44, 19, v44
  v_mul_u32_u24 v45, 12, v44
  v_sub_u32 v45, v43, v45
  v_mul_u32_u24 v44, 3072, v44
  v_lshrrev_b32 v46, 2, v45
  v_lshl_add_u32 v44, v46, 10, v44
  v_and_b32 v45, 3, v45
  v_lshl_add_u32 v44, v45, 4, v44
  v_add_u32 v44, s47, v44
  v_subrev_u32 v23, 2048, v44
  s_waitcnt lgkmcnt(0)
  s_mov_b32 s4, s96
  s_and_b32 s5, s97, 0xffff
  s_mov_b32 s6, 2097152
  s_mov_b32 s7, 0x00020000
  s_mov_b32 s8, s98
  s_and_b32 s9, s99, 0xffff
  s_mov_b32 s10, 1572864
  s_mov_b32 s11, 0x00020000
  s_lshl_b32 s49, s37, 2
  s_add_u32 s49, s49, s38
  s_mul_i32 s47, s49, 12
  v_add_u32 v40, s47, v0
  v_mul_u32_u24 v41, 21846, v40
  v_lshrrev_b32 v41, 16, v41
  v_mul_u32_u24 v42, 3, v41
  v_sub_u32 v42, v40, v42
  v_mul_u32_u24 v41, 3072, v41
  v_lshl_add_u32 v41, v42, 10, v41
  s_mov_b32 s47, 384
  s_mov_b32 exec_lo, 4095
  s_mov_b32 exec_hi, 0
  buffer_load_dword v63, v41, s[8:11], s47 offen
  s_mov_b64 exec, -1
  s_add_u32 s47, s38, 0
  s_lshl_b32 s47, s47, 5
  s_add_u32 s47, s47, s37
  s_lshl_b32 s48, s36, 8
  s_add_u32 s48, s48, s47
  s_sub_i32 s48, s48, 16
  s_max_i32 s48, s48, 0
  s_lshl_b32 s48, s48, 10
  s_cmp_lt_u32 s47, 272
  s_cselect_b32 s48, s48, 0x7f000000
  buffer_load_dwordx4 v[44:47], v2, s[4:7], s48 offen
  s_add_u32 s47, s38, 4
  s_lshl_b32 s47, s47, 5
  s_add_u32 s47, s47, s37
  s_lshl_b32 s48, s36, 8
  s_add_u32 s48, s48, s47
  s_sub_i32 s48, s48, 16
  s_max_i32 s48, s48, 0
  s_lshl_b32 s48, s48, 10
  s_cmp_lt_u32 s47, 272
  s_cselect_b32 s48, s48, 0x7f000000
  buffer_load_dwordx4 v[48:51], v2, s[4:7], s48 offen
  s_add_u32 s47, s38, 8
  s_lshl_b32 s47, s47, 5
  s_add_u32 s47, s47, s37
  s_lshl_b32 s48, s36, 8
  s_add_u32 s48, s48, s47
  s_sub_i32 s48, s48, 16
  s_max_i32 s48, s48, 0
  s_lshl_b32 s48, s48, 10
  s_cmp_lt_u32 s47, 272
  s_cselect_b32 s48, s48, 0x7f000000
  buffer_load_dwordx4 v[52:55], v2, s[4:7], s48 offen
  s_add_u32 m0, s44, 61440
  s_mov_b32 s65, 256
  buffer_load_dwordx4 v16, s[4:7], s65 offen lds
  buffer_load_dwordx4 v17, s[4:7], s65 offen offset:1024 lds
  buffer_load_dwordx4 v18, s[4:7], s65 offen offset:2048 lds
  buffer_load_dwordx4 v19, s[4:7], s65 offen offset:3072 lds
  s_add_u32 m0, s45, 61440
  s_mov_b32 s41, 393216
  buffer_load_dwordx4 v20, s[4:7], s65 offen lds
  s_add_u32 m0, s46, 61440
  s_nop 0
  buffer_load_dwordx4 v21, s[8:11], s41 offen lds
  buffer_load_dwordx4 v22, s[8:11], s41 offen offset:1024 lds
  buffer_load_dwordx4 v23, s[8:11], s41 offen offset:2048 lds
  s_add_u32 m0, s44, 92160
  s_mov_b32 s65, 384
  buffer_load_dwordx4 v16, s[4:7], s65 offen lds
  buffer_load_dwordx4 v17, s[4:7], s65 offen offset:1024 lds
  buffer_load_dwordx4 v18, s[4:7], s65 offen offset:2048 lds
  buffer_load_dwordx4 v19, s[4:7], s65 offen offset:3072 lds
  s_add_u32 m0, s45, 92160
  s_mov_b32 s41, 589824
  buffer_load_dwordx4 v20, s[4:7], s65 offen lds
  s_add_u32 m0, s46, 92160
  s_nop 0
  buffer_load_dwordx4 v21, s[8:11], s41 offen lds
  buffer_load_dwordx4 v22, s[8:11], s41 offen offset:1024 lds
  buffer_load_dwordx4 v23, s[8:11], s41 offen offset:2048 lds
  s_mov_b32 s28, s82
  s_and_b32 s29, s83, 0xffff
  s_mov_b32 s30, 12582912
  s_mov_b32 s31, 0x00020000
  s_mov_b32 s12, s94
  s_and_b32 s13, s95, 0xffff
  s_mov_b32 s14, 524288
  s_mov_b32 s15, 0x00020000
  s_mov_b32 s32, s80
  s_and_b32 s33, s81, 0xffff
  s_mov_b32 s34, 256
  s_mov_b32 s35, 0x00020000
  s_lshl_b32 s49, s2, 2
  s_add_u32 s49, s49, s38
  s_mov_b32 s72, s96
  s_mov_b32 s73, s97
  s_mov_b32 s76, 0
  s_mov_b32 s77, 0
  s_cmp_ge_u32 s49, 128
  s_cselect_b32 s72, s98, s72
  s_cselect_b32 s73, s99, s73
  s_cselect_b32 s76, 1, s76
  s_cselect_b32 s77, 128, s77
  s_cmp_ge_u32 s49, 224
  s_cselect_b32 s72, s94, s72
  s_cselect_b32 s73, s95, s73
  s_cselect_b32 s76, 2, s76
  s_cselect_b32 s77, 224, s77
  s_cmp_ge_u32 s49, 288
  s_cselect_b32 s72, s88, s72
  s_cselect_b32 s73, s89, s73
  s_cselect_b32 s76, 3, s76
  s_cselect_b32 s77, 288, s77
  s_cmp_ge_u32 s49, 512
  s_cselect_b32 s72, s90, s72
  s_cselect_b32 s73, s91, s73
  s_cselect_b32 s76, 4, s76
  s_cselect_b32 s77, 512, s77
  s_cmp_ge_u32 s49, 736
  s_cselect_b32 s72, s84, s72
  s_cselect_b32 s73, s85, s73
  s_cselect_b32 s76, 5, s76
  s_cselect_b32 s77, 736, s77
  s_and_b32 s73, s73, 0xffff
  s_mov_b32 s74, 0x200000
  s_mov_b32 s75, 0x00020000
  s_sub_u32 s77, s49, s77
  s_lshl_b32 s77, s77, 6
  v_add_u32 v58, s77, v0
  v_lshlrev_b32 v57, 7, v58
  v_lshrrev_b32 v56, 2, v58
  v_lshlrev_b32 v56, 10, v56
  v_and_b32 v58, 3, v58
  v_lshl_add_u32 v56, v58, 7, v56
  v_add_u32 v56, 512, v56
  s_cmp_eq_u32 s76, 0
  s_cselect_b64 vcc, -1, 0
  v_cndmask_b32 v58, v57, v56, vcc
  s_cmp_eq_u32 s76, 1
  s_cselect_b32 s77, 786432, 0
  s_cmp_ge_u32 s49, 960
  s_cselect_b32 s77, 0x7f000000, s77
  v_add_u32 v58, s77, v58
  s_lshr_b32 s77, 3, s76
  s_and_b32 s77, s77, 1
  s_cmp_eq_u32 s77, 1
  s_cselect_b32 s77, 0, 0x7f000000
  buffer_load_dword v57, v58, s[72:75], s77 offen
  s_lshl_b32 s47, s36, 9
  s_add_u32 s47, s47, 11796480
  v_lshlrev_b32 v8, 4, v1
  v_add_u32 v8, s47, v8
  buffer_load_dwordx4 v[4:7], v8, s[28:31], 0 offen sc1
  s_lshl_b32 s47, s37, 4
  s_lshl_b32 s48, s38, 2
  s_add_u32 s47, s47, s48
  s_lshl_b32 s47, s47, 10
  buffer_load_dwordx4 v[80:83], v2, s[12:15], s47 offen
  buffer_load_dwordx4 v[84:87], v2, s[12:15], s47 offen offset:1024
  buffer_load_dwordx4 v[88:91], v2, s[12:15], s47 offen offset:2048
  buffer_load_dwordx4 v[92:95], v2, s[12:15], s47 offen offset:3072
  s_barrier
  s_waitcnt vmcnt(22)
  v_lshlrev_b32 v60, 16, v44
  v_and_b32 v61, 0xffff0000, v44
  v_add_f32 v66, v60, v61
  v_mul_f32 v67, v60, v60
  v_fmac_f32 v67, v61, v61
  v_lshlrev_b32 v60, 16, v45
  v_and_b32 v61, 0xffff0000, v45
  v_add_f32 v66, v66, v60
  v_fmac_f32 v67, v60, v60
  v_add_f32 v66, v66, v61
  v_fmac_f32 v67, v61, v61
  v_lshlrev_b32 v60, 16, v46
  v_and_b32 v61, 0xffff0000, v46
  v_add_f32 v66, v66, v60
  v_fmac_f32 v67, v60, v60
  v_add_f32 v66, v66, v61
  v_fmac_f32 v67, v61, v61
  v_lshlrev_b32 v60, 16, v47
  v_and_b32 v61, 0xffff0000, v47
  v_add_f32 v66, v66, v60
  v_fmac_f32 v67, v60, v60
  v_add_f32 v66, v66, v61
  v_fmac_f32 v67, v61, v61
  v_lshlrev_b32 v60, 16, v48
  v_and_b32 v61, 0xffff0000, v48
  v_add_f32 v68, v60, v61
  v_mul_f32 v69, v60, v60
  v_fmac_f32 v69, v61, v61
  v_lshlrev_b32 v60, 16, v49
  v_and_b32 v61, 0xffff0000, v49
  v_add_f32 v68, v68, v60
  v_fmac_f32 v69, v60, v60
  v_add_f32 v68, v68, v61
  v_fmac_f32 v69, v61, v61
  v_lshlrev_b32 v60, 16, v50
  v_and_b32 v61, 0xffff0000, v50
  v_add_f32 v68, v68, v60
  v_fmac_f32 v69, v60, v60
  v_add_f32 v68, v68, v61
  v_fmac_f32 v69, v61, v61
  v_lshlrev_b32 v60, 16, v51
  v_and_b32 v61, 0xffff0000, v51
  v_add_f32 v68, v68, v60
  v_fmac_f32 v69, v60, v60
  v_add_f32 v68, v68, v61
  v_fmac_f32 v69, v61, v61
  v_lshlrev_b32 v60, 16, v52
  v_and_b32 v61, 0xffff0000, v52
  v_add_f32 v70, v60, v61
  v_mul_f32 v71, v60, v60
  v_fmac_f32 v71, v61, v61
  v_lshlrev_b32 v60, 16, v53
  v_and_b32 v61, 0xffff0000, v53
  v_add_f32 v70, v70, v60
  v_fmac_f32 v71, v60, v60
  v_add_f32 v70, v70, v61
  v_fmac_f32 v71, v61, v61
  v_lshlrev_b32 v60, 16, v54
  v_and_b32 v61, 0xffff0000, v54
  v_add_f32 v70, v70, v60
  v_fmac_f32 v71, v60, v60
  v_add_f32 v70, v70, v61
  v_fmac_f32 v71, v61, v61
  v_lshlrev_b32 v60, 16, v55
  v_and_b32 v61, 0xffff0000, v55
  v_add_f32 v70, v70, v60
  v_fmac_f32 v71, v60, v60
  v_add_f32 v70, v70, v61
  v_fmac_f32 v71, v61, v61
  v_permlane32_swap_b32 v66, v67
  v_permlane32_swap_b32 v68, v69
  v_permlane32_swap_b32 v70, v71
  v_add_f32 v66, v66, v67
  v_add_f32 v68, v68, v69
  v_add_f32 v70, v70, v71
  v_mov_b32 v72, v70
  v_permlane16_swap_b32 v66, v68
  s_nop 0
  v_permlane16_swap_b32 v70, v72
  v_add_f32 v66, v66, v68
  v_add_f32 v70, v70, v72
  s_nop 0
  v_add_f32_dpp v66, v66, v66 row_ror:8 row_mask:0xf bank_mask:0xf
  s_nop 1
  v_add_f32_dpp v66, v66, v66 row_ror:4 row_mask:0xf bank_mask:0xf
  s_nop 1
  v_add_f32_dpp v66, v66, v66 row_ror:2 row_mask:0xf bank_mask:0xf
  s_nop 1
  v_add_f32_dpp v66, v66, v66 row_ror:1 row_mask:0xf bank_mask:0xf
  v_add_f32_dpp v70, v70, v70 row_ror:8 row_mask:0xf bank_mask:0xf
  s_nop 1
  v_add_f32_dpp v70, v70, v70 row_ror:4 row_mask:0xf bank_mask:0xf
  s_nop 1
  v_add_f32_dpp v70, v70, v70 row_ror:2 row_mask:0xf bank_mask:0xf
  s_nop 1
  v_add_f32_dpp v70, v70, v70 row_ror:1 row_mask:0xf bank_mask:0xf
  v_mov_b32 v67, v66
  v_mov_b32 v71, v70
  s_nop 0
  v_permlane32_swap_b32 v66, v67
  v_permlane32_swap_b32 v70, v71
  v_mul_f32 v74, 0x3b000000, v66
  v_mul_f32 v68, 0x3b000000, v67
  v_fma_f32 v68, -v74, v74, v68
  v_max_f32 v68, 0, v68
  v_add_f32 v68, 0x3727c5ac, v68
  v_rsq_f32 v75, v68
  v_mul_f32 v76, 0x3b000000, v70
  v_mul_f32 v72, 0x3b000000, v71
  v_fma_f32 v72, -v76, v76, v72
  v_max_f32 v72, 0, v72
  v_add_f32 v72, 0x3727c5ac, v72
  v_rsq_f32 v77, v72
  s_lshl_b32 s47, s38, 5
  s_add_u32 s47, s47, s37
  s_lshl_b32 s47, s47, 3
  s_lshl_b32 s48, s36, 12
  s_add_u32 s47, s47, s48
  s_add_u32 s47, s47, 11665408
  v_lshlrev_b32 v78, 6, v0
  s_mov_b32 exec_lo, 0x00010001
  s_mov_b32 exec_hi, 0
  buffer_store_dwordx2 v[74:75], v78, s[28:31], s47 offen
  s_mov_b64 exec, 1
  buffer_store_dwordx2 v[76:77], v78, s[28:31], s47 offen offset:2048
  s_mov_b64 exec, -1
  s_barrier
  s_add_u32 m0, s44, 0
  s_mov_b32 s65, 512
  buffer_load_dwordx4 v16, s[4:7], s65 offen lds
  buffer_load_dwordx4 v17, s[4:7], s65 offen offset:1024 lds
  buffer_load_dwordx4 v18, s[4:7], s65 offen offset:2048 lds
  buffer_load_dwordx4 v19, s[4:7], s65 offen offset:3072 lds
  s_add_u32 m0, s45, 0
  s_mov_b32 s41, 786432
  buffer_load_dwordx4 v20, s[4:7], s65 offen lds
  s_add_u32 m0, s46, 0
  s_nop 0
  buffer_load_dwordx4 v21, s[8:11], s41 offen lds
  buffer_load_dwordx4 v22, s[8:11], s41 offen offset:1024 lds
  buffer_load_dwordx4 v23, s[8:11], s41 offen offset:2048 lds
  s_waitcnt vmcnt(24)
  s_waitcnt vmcnt(8)
  s_barrier
  s_lshl_b32 s47, s36, 5
  s_add_u32 s47, s47, s37
  s_cmp_eq_u32 s38, 0
  s_cselect_b32 s47, s47, 0x10000
  s_or_b32 s48, s40, 0x40
  v_mov_b32 v40, s47
  v_mov_b32 v41, s48
  s_mov_b64 exec, 1
  buffer_store_byte v41, v40, s[32:35], 0 offen
  s_mov_b64 exec, -1
  s_add_u32 m0, s44, 30720
  s_mov_b32 s65, 640
  buffer_load_dwordx4 v16, s[4:7], s65 offen lds
  buffer_load_dwordx4 v17, s[4:7], s65 offen offset:1024 lds
  buffer_load_dwordx4 v18, s[4:7], s65 offen offset:2048 lds
  buffer_load_dwordx4 v19, s[4:7], s65 offen offset:3072 lds
  s_add_u32 m0, s45, 30720
  s_mov_b32 s41, 983040
  buffer_load_dwordx4 v20, s[4:7], s65 offen lds
  s_add_u32 m0, s46, 30720
  s_nop 0
  buffer_load_dwordx4 v21, s[8:11], s41 offen lds
  buffer_load_dwordx4 v22, s[8:11], s41 offen offset:1024 lds
  buffer_load_dwordx4 v23, s[8:11], s41 offen offset:2048 lds
  s_lshl_b32 s49, s2, 2
  s_add_u32 s49, s49, s38
  s_mov_b32 s20, s84
  s_and_b32 s21, s85, 0xffff
  s_mov_b32 s22, 1835008
  s_mov_b32 s23, 0x00020000
  s_mul_i32 s47, s49, 1792
  v_lshlrev_b32 v40, 7, v0
  s_mov_b32 exec_lo, 0xf
  s_mov_b32 exec_hi, 0
  s_lshl_b32 s48, s49, 9
  buffer_load_dword v57, v40, s[12:15], s48 offen
  s_mov_b32 exec_lo, 0x3fff
  buffer_load_dword v57, v40, s[20:23], s47 offen
  s_mov_b64 exec, -1
  s_barrier
  s_add_u32 m0, s44, 61440
  s_mov_b32 s65, 768
  buffer_load_dwordx4 v16, s[4:7], s65 offen lds
  buffer_load_dwordx4 v17, s[4:7], s65 offen offset:1024 lds
  buffer_load_dwordx4 v18, s[4:7], s65 offen offset:2048 lds
  buffer_load_dwordx4 v19, s[4:7], s65 offen offset:3072 lds
  s_add_u32 m0, s45, 61440
  s_mov_b32 s41, 1179648
  buffer_load_dwordx4 v20, s[4:7], s65 offen lds
  s_add_u32 m0, s46, 61440
  s_nop 0
  buffer_load_dwordx4 v21, s[8:11], s41 offen lds
  buffer_load_dwordx4 v22, s[8:11], s41 offen offset:1024 lds
  buffer_load_dwordx4 v23, s[8:11], s41 offen offset:2048 lds
  s_lshl_b32 s49, s37, 2
  s_add_u32 s49, s49, s38
  s_lshl_b32 s47, s49, 2
  v_add_u32 v41, s47, v0
  v_lshlrev_b32 v41, 10, v41
  s_mov_b32 s47, 384
  s_mov_b32 exec_lo, 15
  s_mov_b32 exec_hi, 0
  buffer_load_dword v63, v41, s[12:15], s47 offen
  s_mov_b64 exec, -1
  s_waitcnt vmcnt(20)
  s_barrier
  s_add_u32 m0, s44, 92160
  s_mov_b32 s65, 896
  buffer_load_dwordx4 v16, s[4:7], s65 offen lds
  buffer_load_dwordx4 v17, s[4:7], s65 offen offset:1024 lds
  buffer_load_dwordx4 v18, s[4:7], s65 offen offset:2048 lds
  buffer_load_dwordx4 v19, s[4:7], s65 offen offset:3072 lds
  s_add_u32 m0, s45, 92160
  s_mov_b32 s41, 1376256
  buffer_load_dwordx4 v20, s[4:7], s65 offen lds
  s_add_u32 m0, s46, 92160
  s_nop 0
  buffer_load_dwordx4 v21, s[8:11], s41 offen lds
  buffer_load_dwordx4 v22, s[8:11], s41 offen offset:1024 lds
  buffer_load_dwordx4 v23, s[8:11], s41 offen offset:2048 lds
  s_waitcnt vmcnt(19)
  s_barrier
  s_and_b32 s79, s36, 3
  s_lshl_b32 s79, s79, 1
  s_cmp_ge_u32 s38, 2
  s_cselect_b32 s16, s90, s88
  s_cselect_b32 s17, s91, s89
  s_and_b32 s17, s17, 0xffff
  s_mov_b32 s18, 1835008
  s_mov_b32 s19, 0x00020000
  s_mov_b32 s20, s84
  s_and_b32 s21, s85, 0xffff
  s_mov_b32 s22, 1835008
  s_mov_b32 s23, 0x00020000
  s_mov_b32 s58, -1
  s_mov_b32 s56, 0x33333333
  s_bitcmp1_b32 s37, 0
  s_cselect_b32 s56, 0xCCCCCCCC, s56
  s_mov_b32 s57, 0x55555555
  s_bitcmp1_b32 s37, 1
  s_cselect_b32 s57, 0xAAAAAAAA, s57
  s_mov_b32 s39, 0
  s_lshl_b32 s54, s38, 17
  s_mul_i32 s55, s38, 458752
  s_lshr_b32 s47, s38, 1
  s_mul_i32 s52, s47, 14464
  s_and_b32 s48, s38, 1
  s_mul_i32 s48, s48, 7168
  s_add_u32 s52, s52, s48
  s_and_b32 s47, s38, 1
  s_mul_i32 s47, s47, 114688
  s_mul_i32 s48, s64, 224
  s_add_u32 s47, s47, s48
  v_add_u32 v43, 0, v0
  v_mul_u32_u24 v44, 4682, v43
  v_lshrrev_b32 v44, 16, v44
  v_mul_u32_u24 v45, 14, v44
  v_sub_u32 v45, v43, v45
  v_mul_u32_u24 v44, 3584, v44
  v_lshl_add_u32 v44, v45, 4, v44
  v_add_u32 v44, s47, v44
  v_mov_b32 v24, v44
  v_add_u32 v43, 64, v0
  v_mul_u32_u24 v44, 4682, v43
  v_lshrrev_b32 v44, 16, v44
  v_mul_u32_u24 v45, 14, v44
  v_sub_u32 v45, v43, v45
  v_mul_u32_u24 v44, 3584, v44
  v_lshl_add_u32 v44, v45, 4, v44
  v_add_u32 v44, s47, v44
  v_subrev_u32 v25, 1024, v44
  v_add_u32 v43, 128, v0
  v_mul_u32_u24 v44, 4682, v43
  v_lshrrev_b32 v44, 16, v44
  v_mul_u32_u24 v45, 14, v44
  v_sub_u32 v45, v43, v45
  v_mul_u32_u24 v44, 3584, v44
  v_lshl_add_u32 v44, v45, 4, v44
  v_add_u32 v44, s47, v44
  v_subrev_u32 v26, 2048, v44
  v_add_u32 v43, 192, v0
  v_mul_u32_u24 v44, 4682, v43
  v_lshrrev_b32 v44, 16, v44
  v_mul_u32_u24 v45, 14, v44
  v_sub_u32 v45, v43, v45
  v_mul_u32_u24 v44, 3584, v44
  v_lshl_add_u32 v44, v45, 4, v44
  v_add_u32 v44, s47, v44
  v_subrev_u32 v27, 3072, v44
  v_add_u32 v43, 256, v0
  v_mul_u32_u24 v44, 4682, v43
  v_lshrrev_b32 v44, 16, v44
  v_mul_u32_u24 v45, 14, v44
  v_sub_u32 v45, v43, v45
  v_mul_u32_u24 v44, 3584, v44
  v_lshl_add_u32 v44, v45, 4, v44
  v_add_u32 v44, s47, v44
  v_mov_b32 v28, v44
  v_add_u32 v43, 320, v0
  v_mul_u32_u24 v44, 4682, v43
  v_lshrrev_b32 v44, 16, v44
  v_mul_u32_u24 v45, 14, v44
  v_sub_u32 v45, v43, v45
  v_mul_u32_u24 v44, 3584, v44
  v_lshl_add_u32 v44, v45, 4, v44
  v_add_u32 v44, s47, v44
  v_subrev_u32 v29, 1024, v44
  v_add_u32 v43, 384, v0
  v_mul_u32_u24 v44, 4682, v43
  v_lshrrev_b32 v44, 16, v44
  v_mul_u32_u24 v45, 14, v44
  v_sub_u32 v45, v43, v45
  v_mul_u32_u24 v44, 3584, v44
  v_lshl_add_u32 v44, v45, 4, v44
  v_add_u32 v44, s47, v44
  v_subrev_u32 v30, 2048, v44
  v_lshrrev_b32 v40, 3, v0
  v_and_b32 v41, 7, v0
  v_bfe_u32 v42, v0, 4, 1
  v_lshlrev_b32 v42, 2, v42
  v_xor_b32 v41, v41, v42
  v_lshlrev_b32 v40, 10, v40
  v_lshl_add_u32 v40, v41, 4, v40
  s_lshl_b32 s47, s63, 7
  v_add_u32 v31, s47, v40
  s_waitcnt vmcnt(9)
  s_barrier
  s_lshl_b32 s47, s36, 5
  v_and_b32 v42, 7, v0
  v_lshlrev_b32 v42, 2, v42
  buffer_load_dword v43, v42, s[32:35], s47 offen sc1
  s_waitcnt vmcnt(0)
  s_mul_i32 s48, s40, 0x01010101
  s_or_b32 s48, s48, 0x40404040
  v_and_b32 v43, 0x4f4f4f4f, v43
  v_cmp_ne_u32 vcc, s48, v43
  s_nop 0
  s_and_b32 vcc_lo, vcc_lo, 0xff
  s_cselect_b32 s47, 1, 0
  s_mov_b32 s59, s47
  s_lshl_b32 s48, s38, 2
  s_add_u32 s48, s48, 153600
  v_mov_b32 v42, s48
  v_mov_b32 v43, s47
  ds_write_b32 v42, v43
  s_waitcnt lgkmcnt(0)
  s_barrier
  s_add_u32 m0, s53, 0
  s_add_u32 s65, s54, 0
  buffer_load_dwordx4 v31, s[12:15], s65 offen lds
  s_add_u32 m0, s53, 4096
  s_add_u32 s65, s54, 8192
  buffer_load_dwordx4 v31, s[12:15], s65 offen lds
  s_add_u32 m0, s53, 8192
  s_add_u32 s65, s54, 16384
  buffer_load_dwordx4 v31, s[12:15], s65 offen lds
  s_add_u32 m0, s53, 12288
  s_add_u32 s65, s54, 24576
  buffer_load_dwordx4 v31, s[12:15], s65 offen lds
  s_add_u32 m0, s53, 16384
  s_add_u32 s65, s54, 32768
  buffer_load_dwordx4 v31, s[12:15], s65 offen lds
  s_add_u32 m0, s53, 20480
  s_add_u32 s65, s54, 40960
  buffer_load_dwordx4 v31, s[12:15], s65 offen lds
  s_add_u32 m0, s53, 24576
  s_add_u32 s65, s54, 49152
  buffer_load_dwordx4 v31, s[12:15], s65 offen lds
  s_add_u32 m0, s53, 28672
  s_add_u32 s65, s54, 57344
  buffer_load_dwordx4 v31, s[12:15], s65 offen lds
  s_barrier
  s_add_u32 m0, s52, 65536
  s_add_u32 s41, s79, 0
  s_and_b32 s41, s41, 7
  s_mul_i32 s41, s41, 229376
  buffer_load_dwordx4 v24, s[16:19], s41 offen lds
  buffer_load_dwordx4 v25, s[16:19], s41 offen offset:1024 lds
  buffer_load_dwordx4 v26, s[16:19], s41 offen offset:2048 lds
  buffer_load_dwordx4 v27, s[16:19], s41 offen offset:3072 lds
  s_add_u32 m0, s52, 69632
  s_add_u32 s41, s79, 0
  s_and_b32 s41, s41, 7
  s_mul_i32 s41, s41, 229376
  buffer_load_dwordx4 v28, s[16:19], s41 offen lds
  buffer_load_dwordx4 v29, s[16:19], s41 offen offset:1024 lds
  buffer_load_dwordx4 v30, s[16:19], s41 offen offset:2048 lds
  s_add_u32 m0, s52, 94336
  s_add_u32 s41, s79, 1
  s_and_b32 s41, s41, 7
  s_mul_i32 s41, s41, 229376
  buffer_load_dwordx4 v24, s[16:19], s41 offen lds
  buffer_load_dwordx4 v25, s[16:19], s41 offen offset:1024 lds
  buffer_load_dwordx4 v26, s[16:19], s41 offen offset:2048 lds
  buffer_load_dwordx4 v27, s[16:19], s41 offen offset:3072 lds
  s_add_u32 m0, s52, 98432
  s_add_u32 s41, s79, 1
  s_and_b32 s41, s41, 7
  s_mul_i32 s41, s41, 229376
  buffer_load_dwordx4 v28, s[16:19], s41 offen lds
  buffer_load_dwordx4 v29, s[16:19], s41 offen offset:1024 lds
  buffer_load_dwordx4 v30, s[16:19], s41 offen offset:2048 lds
  s_add_u32 m0, s53, 32768
  s_add_u32 s65, s54, 65536
  buffer_load_dwordx4 v31, s[12:15], s65 offen lds
  s_add_u32 m0, s53, 36864
  s_add_u32 s65, s54, 73728
  buffer_load_dwordx4 v31, s[12:15], s65 offen lds
  s_add_u32 m0, s53, 40960
  s_add_u32 s65, s54, 81920
  buffer_load_dwordx4 v31, s[12:15], s65 offen lds
  s_add_u32 m0, s53, 45056
  s_add_u32 s65, s54, 90112
  buffer_load_dwordx4 v31, s[12:15], s65 offen lds
  s_add_u32 m0, s53, 49152
  s_add_u32 s65, s54, 98304
  buffer_load_dwordx4 v31, s[12:15], s65 offen lds
  s_add_u32 m0, s53, 53248
  s_add_u32 s65, s54, 106496
  buffer_load_dwordx4 v31, s[12:15], s65 offen lds
  s_add_u32 m0, s53, 57344
  s_add_u32 s65, s54, 114688
  buffer_load_dwordx4 v31, s[12:15], s65 offen lds
  s_add_u32 m0, s53, 61440
  s_add_u32 s65, s54, 122880
  buffer_load_dwordx4 v31, s[12:15], s65 offen lds
  v_mov_b32 v64, 0x3f803f80
  v_dot2_f32_bf16 v66, v80, v64, 0
  s_nop 2
  v_dot2c_f32_bf16 v66, v81, v64
  v_dot2c_f32_bf16 v66, v82, v64
  v_dot2c_f32_bf16 v66, v83, v64
  v_dot2_f32_bf16 v67, v84, v64, 0
  s_nop 2
  v_dot2c_f32_bf16 v67, v85, v64
  v_dot2c_f32_bf16 v67, v86, v64
  v_dot2c_f32_bf16 v67, v87, v64
  v_dot2_f32_bf16 v68, v88, v64, 0
  s_nop 2
  v_dot2c_f32_bf16 v68, v89, v64
  v_dot2c_f32_bf16 v68, v90, v64
  v_dot2c_f32_bf16 v68, v91, v64
  v_dot2_f32_bf16 v69, v92, v64, 0
  s_nop 2
  v_dot2c_f32_bf16 v69, v93, v64
  v_dot2c_f32_bf16 v69, v94, v64
  v_dot2c_f32_bf16 v69, v95, v64
  v_permlane32_swap_b32 v66, v67
  s_nop 1
  v_permlane32_swap_b32 v68, v69
  v_add_f32 v66, v66, v67
  v_add_f32 v68, v68, v69
  s_nop 1
  v_permlane16_swap_b32 v66, v68
  v_add_f32 v66, v66, v68
  s_nop 1
  v_add_f32_dpp v66, v66, v66 row_ror:8 row_mask:0xf bank_mask:0xf
  s_nop 1
  v_add_f32_dpp v66, v66, v66 row_ror:4 row_mask:0xf bank_mask:0xf
  s_nop 1
  v_add_f32_dpp v66, v66, v66 row_ror:2 row_mask:0xf bank_mask:0xf
  s_nop 1
  v_add_f32_dpp v66, v66, v66 row_ror:1 row_mask:0xf bank_mask:0xf
  v_mul_f32 v66, 0x3b000000, v66
  v_cvt_pk_bf16_f32 v67, v66, v66
  v_lshlrev_b32 v68, 16, v67
  v_sub_f32 v68, v66, v68
  v_cvt_pk_bf16_f32 v68, v68, v68
  v_lshrrev_b32 v69, 4, v0
  v_lshrrev_b32 v70, 1, v69
  v_and_b32 v69, 1, v69
  v_lshl_or_b32 v69, v69, 1, v70
  s_lshr_b32 s47, s38, 1
  s_lshl_b32 s47, s47, 3
  s_and_b32 s48, s38, 1
  s_lshl_b32 s48, s48, 4
  s_add_u32 s47, s47, s48
  s_lshl_b32 s48, s37, 5
  s_add_u32 s47, s47, s48
  s_lshl_b32 s48, s36, 11
  s_add_u32 s47, s47, s48
  s_add_u32 s47, s47, 11730944
  v_lshlrev_b32 v69, 1, v69
  s_mov_b32 exec_lo, 0x00010001
  s_mov_b32 exec_hi, 0x00010001
  buffer_store_short v67, v69, s[28:31], s47 offen
  buffer_store_short v68, v69, s[28:31], s47 offen offset:1024
  s_mov_b64 exec, -1
  v_and_b32 v48, 15, v0
  v_lshlrev_b32 v48, 4, v48
  v_bfe_u32 v49, v0, 4, 1
  v_lshl_add_u32 v48, v49, 10, v48
  s_lshl_b32 s47, s36, 11
  s_lshl_b32 s48, s38, 8
  s_add_u32 s47, s47, s48
  s_add_u32 s62, s47, 11730944
  s_lshl_b32 s48, s38, 9
  s_add_u32 s63, s48, 153856
  s_waitcnt vmcnt(0)
  s_barrier
  s_mov_b32 s39, 0
  s_cmp_eq_u32 s59, 0
  s_cbranch_scc1 H_100001
  s_lshl_b32 s47, s36, 5
  v_and_b32 v42, 7, v0
  v_lshlrev_b32 v42, 2, v42
  buffer_load_dword v43, v42, s[32:35], s47 offen sc1
  s_waitcnt vmcnt(0)
  s_mul_i32 s48, s40, 0x01010101
  v_xor_b32 v43, s48, v43
  v_and_b32 v43, 0x0f0f0f0f, v43
  v_cmp_ne_u32 vcc, 0, v43
  s_nop 0
  s_and_b32 vcc_lo, vcc_lo, 0xff
  s_cselect_b32 s39, 1, 0
H_100001:
  s_cmp_lg_u32 s38, 0
  s_cbranch_scc1 H_100002
  v_add_u32 v4, 1, v4
  s_lshl_b64 s[60:61], 1, s37
  s_cmp_lg_u32 s39, 0
  s_cbranch_scc1 H_100004
  s_mov_b64 exec, s[60:61]
  buffer_store_dword v4, v8, s[28:31], 0 offen offset:0
  s_branch H_100005
H_100004:
  buffer_wbl2 sc1
  s_waitcnt vmcnt(0)
  s_mov_b64 exec, s[60:61]
  buffer_store_dword v4, v8, s[28:31], 0 offen offset:0 sc1
H_100005:
  s_mov_b64 exec, -1
H_100003:
  buffer_load_dword v44, v8, s[28:31], 0 offen offset:0 sc1
  s_waitcnt vmcnt(0)
  v_cmp_ne_u32 vcc, v44, v4
  s_nop 0
  s_and_b32 vcc_lo, vcc_lo, s58
  s_cbranch_scc1 H_100003
  s_cmp_lg_u32 s39, 0
  s_cbranch_scc0 H_100006
  buffer_inv sc1
  s_waitcnt vmcnt(0)
H_100006:
  s_barrier
  s_branch H_100008
H_100002:
  s_barrier
H_100008:
  s_mov_b32 m0, s63
  s_mov_b32 exec_hi, 0
  buffer_load_dwordx4 v48, s[28:31], s62 offen sc1 lds
  s_mov_b32 exec_hi, -1
  s_waitcnt vmcnt(0)
  s_barrier
  s_add_u32 m0, s52, 123136
  s_add_u32 s41, s79, 2
  s_and_b32 s41, s41, 7
  s_mul_i32 s41, s41, 229376
  buffer_load_dwordx4 v24, s[16:19], s41 offen lds
  buffer_load_dwordx4 v25, s[16:19], s41 offen offset:1024 lds
  buffer_load_dwordx4 v26, s[16:19], s41 offen offset:2048 lds
  buffer_load_dwordx4 v27, s[16:19], s41 offen offset:3072 lds
  s_add_u32 m0, s52, 127232
  s_add_u32 s41, s79, 2
  s_and_b32 s41, s41, 7
  s_mul_i32 s41, s41, 229376
  buffer_load_dwordx4 v28, s[16:19], s41 offen lds
  buffer_load_dwordx4 v29, s[16:19], s41 offen offset:1024 lds
  buffer_load_dwordx4 v30, s[16:19], s41 offen offset:2048 lds
  s_add_u32 s41, s79, 3
  s_and_b32 s41, s41, 7
  s_mul_i32 s41, s41, 229376
  buffer_load_dwordx4 v[96:99], v24, s[16:19], s41 offen
  buffer_load_dwordx4 v[100:103], v25, s[16:19], s41 offen offset:1024
  buffer_load_dwordx4 v[104:107], v26, s[16:19], s41 offen offset:2048
  buffer_load_dwordx4 v[108:111], v27, s[16:19], s41 offen offset:3072
  buffer_load_dwordx4 v[112:115], v28, s[16:19], s41 offen
  buffer_load_dwordx4 v[116:119], v29, s[16:19], s41 offen offset:1024
  buffer_load_dwordx4 v[120:123], v30, s[16:19], s41 offen offset:2048
  s_lshl_b32 s49, s37, 2
  s_add_u32 s49, s49, s38
  s_mul_i32 s47, s49, 14
  v_add_u32 v41, s47, v0
  v_lshlrev_b32 v41, 10, v41
  s_mov_b32 s47, 384
  s_mov_b32 exec_lo, 16383
  s_mov_b32 exec_hi, 0
  buffer_load_dword v63, v41, s[20:23], s47 offen
  s_mov_b64 exec, -1
  s_barrier
  s_barrier
  s_cmp_lg_u32 s38, 0
  s_cbranch_scc1 H_100009
  v_add_u32 v5, 1, v5
  s_lshl_b64 s[60:61], 1, s37
  s_cmp_lg_u32 s39, 0
  s_cbranch_scc1 H_100011
  s_mov_b64 exec, s[60:61]
  buffer_store_dword v5, v8, s[28:31], 0 offen offset:4
  s_branch H_100012
H_100011:
  buffer_wbl2 sc1
  s_waitcnt vmcnt(0)
  s_mov_b64 exec, s[60:61]
  buffer_store_dword v5, v8, s[28:31], 0 offen offset:4 sc1
H_100012:
  s_mov_b64 exec, -1
  s_waitcnt vmcnt(1)
  v_add_u32 v40, s52, v2
  ds_write_b128 v40, v[96:99] offset:0
  ds_write_b128 v40, v[100:103] offset:1024
  ds_write_b128 v40, v[104:107] offset:2048
  ds_write_b128 v40, v[108:111] offset:3072
  ds_write_b128 v40, v[112:115] offset:4096
  ds_write_b128 v40, v[116:119] offset:5120
  ds_write_b128 v40, v[120:123] offset:6144
  s_waitcnt lgkmcnt(0)
H_100010:
  buffer_load_dword v44, v8, s[28:31], 0 offen offset:4 sc1
  s_waitcnt vmcnt(0)
  v_cmp_ne_u32 vcc, v44, v5
  s_nop 0
  s_and_b32 vcc_lo, vcc_lo, s56
  s_cbranch_scc1 H_100010
  s_cmp_lg_u32 s39, 0
  s_cbranch_scc0 H_100013
  buffer_inv sc1
  s_waitcnt vmcnt(0)
H_100013:
  s_barrier
  s_branch H_100015
H_100009:
  s_waitcnt vmcnt(1)
  v_add_u32 v40, s52, v2
  ds_write_b128 v40, v[96:99] offset:0
  ds_write_b128 v40, v[100:103] offset:1024
  ds_write_b128 v40, v[104:107] offset:2048
  ds_write_b128 v40, v[108:111] offset:3072
  ds_write_b128 v40, v[112:115] offset:4096
  ds_write_b128 v40, v[116:119] offset:5120
  ds_write_b128 v40, v[120:123] offset:6144
  s_waitcnt lgkmcnt(0)
  s_barrier
H_100015:
  s_barrier
  s_add_u32 m0, s52, 28800
  s_add_u32 s41, s79, 4
  s_and_b32 s41, s41, 7
  s_mul_i32 s41, s41, 229376
  buffer_load_dwordx4 v24, s[16:19], s41 offen lds
  buffer_load_dwordx4 v25, s[16:19], s41 offen offset:1024 lds
  buffer_load_dwordx4 v26, s[16:19], s41 offen offset:2048 lds
  buffer_load_dwordx4 v27, s[16:19], s41 offen offset:3072 lds
  s_add_u32 m0, s52, 32896
  s_add_u32 s41, s79, 4
  s_and_b32 s41, s41, 7
  s_mul_i32 s41, s41, 229376
  buffer_load_dwordx4 v28, s[16:19], s41 offen lds
  buffer_load_dwordx4 v29, s[16:19], s41 offen offset:1024 lds
  buffer_load_dwordx4 v30, s[16:19], s41 offen offset:2048 lds
  s_add_u32 s65, s55, 286720
  buffer_load_dwordx4 v[96:99], v31, s[20:23], s65 offen
  s_add_u32 s65, s55, 294912
  buffer_load_dwordx4 v[100:103], v31, s[20:23], s65 offen
  s_add_u32 s65, s55, 303104
  buffer_load_dwordx4 v[104:107], v31, s[20:23], s65 offen
  s_add_u32 s65, s55, 311296
  buffer_load_dwordx4 v[108:111], v31, s[20:23], s65 offen
  s_add_u32 s65, s55, 319488
  buffer_load_dwordx4 v[112:115], v31, s[20:23], s65 offen
  s_add_u32 s65, s55, 327680
  buffer_load_dwordx4 v[116:119], v31, s[20:23], s65 offen
  s_add_u32 s65, s55, 335872
  buffer_load_dwordx4 v[120:123], v31, s[20:23], s65 offen
  s_barrier
  s_add_u32 m0, s52, 65536
  s_add_u32 s41, s79, 5
  s_and_b32 s41, s41, 7
  s_mul_i32 s41, s41, 229376
  buffer_load_dwordx4 v24, s[16:19], s41 offen lds
  buffer_load_dwordx4 v25, s[16:19], s41 offen offset:1024 lds
  buffer_load_dwordx4 v26, s[16:19], s41 offen offset:2048 lds
  buffer_load_dwordx4 v27, s[16:19], s41 offen offset:3072 lds
  s_add_u32 m0, s52, 69632
  s_add_u32 s41, s79, 5
  s_and_b32 s41, s41, 7
  s_mul_i32 s41, s41, 229376
  buffer_load_dwordx4 v28, s[16:19], s41 offen lds
  buffer_load_dwordx4 v29, s[16:19], s41 offen offset:1024 lds
  buffer_load_dwordx4 v30, s[16:19], s41 offen offset:2048 lds
  s_barrier
  s_add_u32 m0, s52, 94336
  s_add_u32 s41, s79, 6
  s_and_b32 s41, s41, 7
  s_mul_i32 s41, s41, 229376
  buffer_load_dwordx4 v24, s[16:19], s41 offen lds
  buffer_load_dwordx4 v25, s[16:19], s41 offen offset:1024 lds
  buffer_load_dwordx4 v26, s[16:19], s41 offen offset:2048 lds
  buffer_load_dwordx4 v27, s[16:19], s41 offen offset:3072 lds
  s_add_u32 m0, s52, 98432
  s_add_u32 s41, s79, 6
  s_and_b32 s41, s41, 7
  s_mul_i32 s41, s41, 229376
  buffer_load_dwordx4 v28, s[16:19], s41 offen lds
  buffer_load_dwordx4 v29, s[16:19], s41 offen offset:1024 lds
  buffer_load_dwordx4 v30, s[16:19], s41 offen offset:2048 lds
  s_waitcnt vmcnt(21)
  s_barrier
  s_add_u32 m0, s52, 123136
  s_add_u32 s41, s79, 7
  s_and_b32 s41, s41, 7
  s_mul_i32 s41, s41, 229376
  buffer_load_dwordx4 v24, s[16:19], s41 offen lds
  buffer_load_dwordx4 v25, s[16:19], s41 offen offset:1024 lds
  buffer_load_dwordx4 v26, s[16:19], s41 offen offset:2048 lds
  buffer_load_dwordx4 v27, s[16:19], s41 offen offset:3072 lds
  s_add_u32 m0, s52, 127232
  s_add_u32 s41, s79, 7
  s_and_b32 s41, s41, 7
  s_mul_i32 s41, s41, 229376
  buffer_load_dwordx4 v28, s[16:19], s41 offen lds
  buffer_load_dwordx4 v29, s[16:19], s41 offen offset:1024 lds
  buffer_load_dwordx4 v30, s[16:19], s41 offen offset:2048 lds
  s_waitcnt vmcnt(14)
  s_barrier
  s_add_u32 m0, s53, 0
  s_add_u32 s65, s55, 0
  buffer_load_dwordx4 v31, s[20:23], s65 offen lds
  s_add_u32 m0, s53, 4096
  s_add_u32 s65, s55, 8192
  buffer_load_dwordx4 v31, s[20:23], s65 offen lds
  s_add_u32 m0, s53, 8192
  s_add_u32 s65, s55, 16384
  buffer_load_dwordx4 v31, s[20:23], s65 offen lds
  s_add_u32 m0, s53, 12288
  s_add_u32 s65, s55, 24576
  buffer_load_dwordx4 v31, s[20:23], s65 offen lds
  s_add_u32 m0, s53, 16384
  s_add_u32 s65, s55, 32768
  buffer_load_dwordx4 v31, s[20:23], s65 offen lds
  s_add_u32 m0, s53, 20480
  s_add_u32 s65, s55, 40960
  buffer_load_dwordx4 v31, s[20:23], s65 offen lds
  s_add_u32 m0, s53, 24576
  s_add_u32 s65, s55, 49152
  buffer_load_dwordx4 v31, s[20:23], s65 offen lds
  s_waitcnt vmcnt(14)
  s_barrier
  s_add_u32 m0, s53, 28800
  s_add_u32 s65, s55, 57344
  buffer_load_dwordx4 v31, s[20:23], s65 offen lds
  s_add_u32 m0, s53, 32896
  s_add_u32 s65, s55, 65536
  buffer_load_dwordx4 v31, s[20:23], s65 offen lds
  s_add_u32 m0, s53, 36992
  s_add_u32 s65, s55, 73728
  buffer_load_dwordx4 v31, s[20:23], s65 offen lds
  s_add_u32 m0, s53, 41088
  s_add_u32 s65, s55, 81920
  buffer_load_dwordx4 v31, s[20:23], s65 offen lds
  s_add_u32 m0, s53, 45184
  s_add_u32 s65, s55, 90112
  buffer_load_dwordx4 v31, s[20:23], s65 offen lds
  s_add_u32 m0, s53, 49280
  s_add_u32 s65, s55, 98304
  buffer_load_dwordx4 v31, s[20:23], s65 offen lds
  s_add_u32 m0, s53, 53376
  s_add_u32 s65, s55, 106496
  buffer_load_dwordx4 v31, s[20:23], s65 offen lds
  s_waitcnt vmcnt(14)
  s_barrier
  s_add_u32 m0, s53, 65536
  s_add_u32 s65, s55, 114688
  buffer_load_dwordx4 v31, s[20:23], s65 offen lds
  s_add_u32 m0, s53, 69632
  s_add_u32 s65, s55, 122880
  buffer_load_dwordx4 v31, s[20:23], s65 offen lds
  s_add_u32 m0, s53, 73728
  s_add_u32 s65, s55, 131072
  buffer_load_dwordx4 v31, s[20:23], s65 offen lds
  s_add_u32 m0, s53, 77824
  s_add_u32 s65, s55, 139264
  buffer_load_dwordx4 v31, s[20:23], s65 offen lds
  s_add_u32 m0, s53, 81920
  s_add_u32 s65, s55, 147456
  buffer_load_dwordx4 v31, s[20:23], s65 offen lds
  s_add_u32 m0, s53, 86016
  s_add_u32 s65, s55, 155648
  buffer_load_dwordx4 v31, s[20:23], s65 offen lds
  s_add_u32 m0, s53, 90112
  s_add_u32 s65, s55, 163840
  buffer_load_dwordx4 v31, s[20:23], s65 offen lds
  s_add_u32 s65, s55, 344064
  buffer_load_dwordx4 v[124:127], v31, s[20:23], s65 offen
  s_add_u32 s65, s55, 352256
  buffer_load_dwordx4 v[128:131], v31, s[20:23], s65 offen
  s_add_u32 s65, s55, 360448
  buffer_load_dwordx4 v[132:135], v31, s[20:23], s65 offen
  s_add_u32 s65, s55, 368640
  buffer_load_dwordx4 v[136:139], v31, s[20:23], s65 offen
  s_add_u32 s65, s55, 376832
  buffer_load_dwordx4 v[140:143], v31, s[20:23], s65 offen
  s_add_u32 s65, s55, 385024
  buffer_load_dwordx4 v[144:147], v31, s[20:23], s65 offen
  s_add_u32 s65, s55, 393216
  buffer_load_dwordx4 v[148:151], v31, s[20:23], s65 offen
  s_barrier
  s_add_u32 m0, s53, 94336
  s_add_u32 s65, s55, 172032
  buffer_load_dwordx4 v31, s[20:23], s65 offen lds
  s_add_u32 m0, s53, 98432
  s_add_u32 s65, s55, 180224
  buffer_load_dwordx4 v31, s[20:23], s65 offen lds
  s_add_u32 m0, s53, 102528
  s_add_u32 s65, s55, 188416
  buffer_load_dwordx4 v31, s[20:23], s65 offen lds
  s_add_u32 m0, s53, 106624
  s_add_u32 s65, s55, 196608
  buffer_load_dwordx4 v31, s[20:23], s65 offen lds
  s_add_u32 m0, s53, 110720
  s_add_u32 s65, s55, 204800
  buffer_load_dwordx4 v31, s[20:23], s65 offen lds
  s_add_u32 m0, s53, 114816
  s_add_u32 s65, s55, 212992
  buffer_load_dwordx4 v31, s[20:23], s65 offen lds
  s_add_u32 m0, s53, 118912
  s_add_u32 s65, s55, 221184
  buffer_load_dwordx4 v31, s[20:23], s65 offen lds
  s_add_u32 s65, s55, 401408
  buffer_load_dwordx4 v[152:155], v31, s[20:23], s65 offen
  s_add_u32 s65, s55, 409600
  buffer_load_dwordx4 v[156:159], v31, s[20:23], s65 offen
  s_add_u32 s65, s55, 417792
  buffer_load_dwordx4 v[160:163], v31, s[20:23], s65 offen
  s_add_u32 s65, s55, 425984
  buffer_load_dwordx4 v[164:167], v31, s[20:23], s65 offen
  s_add_u32 s65, s55, 434176
  buffer_load_dwordx4 v[168:171], v31, s[20:23], s65 offen
  s_add_u32 s65, s55, 442368
  buffer_load_dwordx4 v[172:175], v31, s[20:23], s65 offen
  s_add_u32 s65, s55, 450560
  buffer_load_dwordx4 v[176:179], v31, s[20:23], s65 offen
  s_barrier
  s_add_u32 m0, s53, 123136
  s_add_u32 s65, s55, 229376
  buffer_load_dwordx4 v31, s[20:23], s65 offen lds
  s_add_u32 m0, s53, 127232
  s_add_u32 s65, s55, 237568
  buffer_load_dwordx4 v31, s[20:23], s65 offen lds
  s_add_u32 m0, s53, 131328
  s_add_u32 s65, s55, 245760
  buffer_load_dwordx4 v31, s[20:23], s65 offen lds
  s_add_u32 m0, s53, 135424
  s_add_u32 s65, s55, 253952
  buffer_load_dwordx4 v31, s[20:23], s65 offen lds
  s_add_u32 m0, s53, 139520
  s_add_u32 s65, s55, 262144
  buffer_load_dwordx4 v31, s[20:23], s65 offen lds
  s_add_u32 m0, s53, 143616
  s_add_u32 s65, s55, 270336
  buffer_load_dwordx4 v31, s[20:23], s65 offen lds
  s_add_u32 m0, s53, 147712
  s_add_u32 s65, s55, 278528
  buffer_load_dwordx4 v31, s[20:23], s65 offen lds
  s_waitcnt vmcnt(0)
  s_barrier
  s_cmp_lg_u32 s38, 0
  s_cbranch_scc1 H_100016
  v_add_u32 v6, 1, v6
  s_lshl_b64 s[60:61], 1, s37
  s_cmp_lg_u32 s39, 0
  s_cbranch_scc1 H_100018
  s_mov_b64 exec, s[60:61]
  buffer_store_dword v6, v8, s[28:31], 0 offen offset:8
  s_branch H_100019
H_100018:
  buffer_wbl2 sc1
  s_waitcnt vmcnt(0)
  s_mov_b64 exec, s[60:61]
  buffer_store_dword v6, v8, s[28:31], 0 offen offset:8 sc1
H_100019:
  s_mov_b64 exec, -1
H_100017:
  buffer_load_dword v44, v8, s[28:31], 0 offen offset:8 sc1
  s_waitcnt vmcnt(0)
  v_cmp_ne_u32 vcc, v44, v6
  s_nop 0
  s_and_b32 vcc_lo, vcc_lo, s57
  s_cbranch_scc1 H_100017
  s_cmp_lg_u32 s39, 0
  s_cbranch_scc0 H_100020
  buffer_inv sc1
  s_waitcnt vmcnt(0)
H_100020:
  s_barrier
  s_branch H_100022
H_100016:
  s_barrier
H_100022:
  s_barrier
  v_add_u32 v40, s53, v2
  v_add_u32 v41, 0x10000, v40
  v_add_u32 v42, 0x20000, v40
  ds_write_b128 v40, v[96:99] offset:0
  ds_write_b128 v40, v[100:103] offset:4096
  ds_write_b128 v40, v[104:107] offset:8192
  ds_write_b128 v40, v[108:111] offset:12288
  ds_write_b128 v40, v[112:115] offset:16384
  ds_write_b128 v40, v[116:119] offset:20480
  ds_write_b128 v40, v[120:123] offset:24576
  ds_write_b128 v40, v[124:127] offset:28800
  ds_write_b128 v40, v[128:131] offset:32896
  ds_write_b128 v40, v[132:135] offset:36992
  ds_write_b128 v40, v[136:139] offset:41088
  ds_write_b128 v40, v[140:143] offset:45184
  s_waitcnt lgkmcnt(0)
  s_barrier
  v_add_u32 v40, s53, v2
  v_add_u32 v41, 0x10000, v40
  v_add_u32 v42, 0x20000, v40
  ds_write_b128 v40, v[144:147] offset:49280
  ds_write_b128 v40, v[148:151] offset:53376
  ds_write_b128 v41, v[152:155] offset:0
  ds_write_b128 v41, v[156:159] offset:4096
  ds_write_b128 v41, v[160:163] offset:8192
  ds_write_b128 v41, v[164:167] offset:12288
  ds_write_b128 v41, v[168:171] offset:16384
  ds_write_b128 v41, v[172:175] offset:20480
  ds_write_b128 v41, v[176:179] offset:24576
  s_waitcnt lgkmcnt(0)
  s_barrier
  s_barrier
  s_endpgm
L_code_end:
.set CODE_BYTES, L_code_end - sequential_preLN__sliding_local_dilated__glu_gated_glu__prompt_kernel
.section .rodata,"a"
.p2align 6
.amdhsa_kernel sequential_preLN__sliding_local_dilated__glu_gated_glu__prompt_kernel
  .amdhsa_next_free_vgpr 256
  .amdhsa_next_free_sgpr 102
  .amdhsa_accum_offset 192
  .amdhsa_group_segment_fixed_size 0
  .amdhsa_kernarg_size 80
  .amdhsa_user_sgpr_count 2
  .amdhsa_user_sgpr_kernarg_segment_ptr 1
  .amdhsa_system_sgpr_workgroup_id_x 1
.end_amdhsa_kernel
```
